```python
import torch

def _softmax(x, axis=-1):
    return torch.softmax(x, dim=axis)
def _gelu(x):
    return torch.nn.functional.gelu(x, approximate="tanh")
def _silu(x):
    return torch.nn.functional.silu(x)
def _sigmoid(x):
    return torch.sigmoid(x)
def _layernorm(x, axis=-1, eps=1e-5):
    m = x.mean(dim=axis, keepdim=True)
    v = x.var(dim=axis, keepdim=True, unbiased=False)
    return (x - m) / torch.sqrt(v + eps)
def _scatter_add(tgt, idx, src, axis=0):
    return tgt.clone().index_add_(axis, idx, src)
def _segment_sum(src, seg, n):
    out = torch.zeros((n,) + src.shape[1:], dtype=src.dtype)
    return out.index_add_(0, seg, src)
def _pad(x, pw):
    flat = tuple(v for pair in reversed(pw) for v in pair)
    return torch.nn.functional.pad(x, flat)

kernel_name = 'gated_mix__sliding_block__moe_arch_mod__prompt'

def setup_inputs():

    _w = (lambda a: (lambda t: t.to(torch.bfloat16) if t.is_floating_point() else t)(torch.as_tensor(a)))
    def _A_setup():
        B, S, D = 1, 2048, 576
        return {
            "x": _w((lambda *s: torch.randn(*s, dtype=torch.bfloat16) * 0.05)(B, S, D)),
            "wqkv": _w((lambda *s: torch.randn(*s, dtype=torch.bfloat16) * 0.8)(D, 3 * D)),
            "wo": _w((lambda *s: torch.randn(*s, dtype=torch.bfloat16) * 0.05)(D, D)),
        }
    _A_in = _A_setup()

    def _B_setup():
        B, S, D, F, C = 1, 2048, 576, 4608, 1
        return {
            "x": _w((lambda *s: torch.randn(*s, dtype=torch.bfloat16) * 0.05)(B, S, D)),
            "w_r": _w((lambda *s: torch.randn(*s, dtype=torch.bfloat16) * 3.2)(D)),
            "w_gate": _w((lambda *s: torch.randn(*s, dtype=torch.bfloat16) * 0.2)(D, F)),
            "w_up": _w((lambda *s: torch.randn(*s, dtype=torch.bfloat16) * 0.2)(D, F)),
            "w_down": _w((lambda *s: torch.randn(*s, dtype=torch.bfloat16) * 0.2)(F, D)),
        }
    _B_in = _B_setup()

    return {
        "A_x": _A_in["x"],
        "A_wqkv": _A_in["wqkv"],
        "A_wo": _A_in["wo"],
        "B_x": _B_in["x"],
        "B_w_r": _B_in["w_r"],
        "B_w_gate": _B_in["w_gate"],
        "B_w_up": _B_in["w_up"],
        "B_w_down": _B_in["w_down"],
        "gate_w": _w((lambda *s: torch.randn(*s, dtype=torch.bfloat16) * 0.05)(576) * 16.0),
    }

def reference(A_x, A_wqkv, A_wo, B_x, B_w_r, B_w_gate, B_w_up, B_w_down, gate_w):
    def _A_ref(x, wqkv, wo):
        B, S, D = x.shape
        H = 32; Dh = D // H; W = 256
        qkv = (lambda x, *d: x.permute(*d))((x @ wqkv).reshape(B, S, 3, H, Dh), 2, 0, 3, 1, 4)
        q, k, v = qkv[0], qkv[1], qkv[2]
        scores = torch.einsum("bhqd,bhkd->bhqk", q, k) * (Dh ** -0.5)
        idx = torch.arange(S)
        mask = (idx[:, None] - idx[None, :] >= 0) & (idx[:, None] - idx[None, :] < W)
        scores = torch.where(mask[None, None], scores, -1e9)
        p = _softmax(scores, axis=-1)
        o = torch.einsum("bhqk,bhkd->bhqd", p, v)
        return (lambda x, *d: x.permute(*d))(o, 0, 2, 1, 3).reshape(B, S, D) @ wo

    def _B_ref(x, w_r, w_gate, w_up, w_down):
        B, S, D = x.shape
        C = 1
        r = x @ w_r
        idx = torch.argsort(-r, axis=-1)[:, :C]
        idx_e = (lambda x, n, axis: torch.repeat_interleave(x, n, dim=axis))(idx.reshape(B, C, 1), D, axis=2)
        x_sel = (lambda x, i, axis: torch.take_along_dim(x, i, dim=axis))(x, idx_e, axis=1)
        g = _silu(x_sel @ w_gate)
        u = x_sel @ w_up
        y = (g * u) @ w_down
        r_sel = _sigmoid((lambda x, i, axis: torch.take_along_dim(x, i, dim=axis))(r, idx, axis=1))
        y = y * r_sel.reshape(B, C, 1)
        b_off = (torch.arange(B) * S).reshape(B, 1)
        flat_idx = (idx + b_off).reshape(B * C)
        zero = (x * 0.0).reshape(B * S, D)
        upd = _scatter_add(zero, flat_idx, y.reshape(B * C, D), axis=0)
        return x + upd.reshape(B, S, D)

    x = A_x
    g = _sigmoid((x * gate_w).sum(-1, keepdims=True))
    a = _A_ref(x, A_wqkv, A_wo)
    b = _B_ref(x, B_w_r, B_w_gate, B_w_up, B_w_down)
    return g * a + (1 - g) * b
```

```asm
; @launch grid=(256,1,1) block=(768,1,1) lds=162304
.amdgcn_target "amdgcn-amd-amdhsa--gfx950"
.text
.globl gated_mix__sliding_block__moe_arch_mod__prompt_kernel
.p2align 8
.type gated_mix__sliding_block__moe_arch_mod__prompt_kernel,@function
gated_mix__sliding_block__moe_arch_mod__prompt_kernel:
  s_cmp_ge_u32 s2, 256
  s_cbranch_scc1 L_end
  s_load_dwordx4 s[4:7], s[0:1], 0
  s_load_dwordx2 s[8:9], s[0:1], 88
  s_load_dwordx2 s[10:11], s[0:1], 72
  s_load_dwordx2 s[14:15], s[0:1], 56
  s_load_dwordx2 s[28:29], s[0:1], 16
  v_lshrrev_b32 v1, 6, v0
  v_and_b32 v0, 63, v0
  v_readfirstlane_b32 s3, v1
  s_and_b32 s30, s2, 3
  s_bfe_u32 s31, s2, 0x10002
  s_lshr_b32 s32, s2, 3
  s_cmp_ge_u32 s32, 24
  s_cbranch_scc1 L_sp
  s_cmp_ge_u32 s3, 8
  s_cbranch_scc1 L_help
  s_lshr_b32 s33, s32, 1
  s_mul_i32 s33, s33, 43
  s_lshr_b32 s33, s33, 7
  s_mul_i32 s34, s33, 6
  s_sub_u32 s34, s32, s34
  s_and_b32 s35, s34, 1
  s_lshr_b32 s34, s34, 1
  s_lshl_b32 s34, s34, 2
  s_add_u32 s34, s34, s35
  s_and_b32 s35, s2, 1
  s_lshl_b32 s35, s35, 1
  s_add_u32 s34, s34, s35
  s_bfe_u32 s35, s2, 0x20001
  s_lshl_b32 s35, s35, 2
  s_add_u32 s35, s35, s33
  s_cmp_lt_u32 s3, 4
  s_cbranch_scc1 L_comp
  s_cmp_lt_u32 s3, 6
  s_cbranch_scc0 L_ldw
  s_sub_u32 s36, s3, 4
  v_and_b32 v7, 15, v0
  s_lshl_b32 s41, s33, 4
  s_lshl_b32 s42, s36, 6
  s_add_u32 s41, s41, s42
  v_add_u32 v7, s41, v7
  v_mul_u32_u24 v7, 3456, v7
  v_lshrrev_b32 v1, 4, v0
  v_lshl_add_u32 v7, v1, 7, v7
  v_lshrrev_b32 v1, 3, v0
  s_mul_i32 s39, s35, 147456
  s_mul_i32 s46, s34, 288
  s_and_b32 s46, s46, 0xffffff80
  s_sub_u32 s47, 1990656, s46
  v_mul_u32_u24 v1, 1152, v1
  v_lshrrev_b32 v2, 4, v0
  v_and_b32 v3, 7, v0
  v_xor_b32 v3, v3, v2
  v_lshl_add_u32 v4, v3, 4, v1
  v_xor_b32 v3, 4, v3
  v_lshl_add_u32 v5, v3, 4, v1
  v_add_u32 v5, 9216, v5
  s_mul_i32 s37, s36, 73728
  s_lshl_b32 s38, s36, 13
  s_waitcnt lgkmcnt(0)
  s_add_u32 s20, s6, s46
  s_addc_u32 s21, s7, 0
  s_and_b32 s21, s21, 0xffff
  s_mov_b32 s22, s47
  s_mov_b32 s23, 0x20000
  s_mov_b32 exec_hi, 0xffff
  buffer_load_dword v20, v7, s[20:23], 0 offen
  s_mov_b64 exec, -1
  s_add_u32 s16, s4, s39
  s_addc_u32 s17, s5, 0
  s_and_b32 s17, s17, 0xffff
  s_mov_b32 s18, 147456
  s_mov_b32 s19, 0x20000
  s_mul_i32 s41, s33, 6
  s_sub_u32 s41, s32, s41
  s_mul_i32 s41, s41, 22
  v_add_u32 v6, s41, v0
  v_mul_u32_u24 v6, 1152, v6
  s_lshl_b32 s41, s36, 7
  s_mov_b64 exec, 0x3fffff
  buffer_load_dword v21, v6, s[16:19], s41 offen
  s_mov_b64 exec, -1
  s_mov_b32 s64, 10371072
  s_load_dword s65, s[8:9], s64
  s_mul_i32 s55, s34, 589824
  s_mul_i32 s56, s35, 9216
  s_add_u32 s55, s55, s56
  s_lshl_b32 s56, s3, 10
  s_add_u32 s55, s55, s56
  s_add_u32 s57, s3, 0
  s_mul_i32 s57, s57, 57
  s_lshr_b32 s57, s57, 9
  s_mul_i32 s57, s57, 138240
  s_add_u32 s57, s57, s55
  s_add_u32 s50, s57, 0
  s_add_u32 s57, s3, 8
  s_mul_i32 s57, s57, 57
  s_lshr_b32 s57, s57, 9
  s_mul_i32 s57, s57, 138240
  s_add_u32 s57, s57, s55
  s_add_u32 s51, s57, 8192
  s_add_u32 s57, s3, 16
  s_mul_i32 s57, s57, 57
  s_lshr_b32 s57, s57, 9
  s_mul_i32 s57, s57, 138240
  s_add_u32 s57, s57, s55
  s_add_u32 s52, s57, 16384
  s_add_u32 s57, s3, 24
  s_mul_i32 s57, s57, 57
  s_lshr_b32 s57, s57, 9
  s_mul_i32 s57, s57, 138240
  s_add_u32 s57, s57, s55
  s_add_u32 s53, s57, 24576
  s_add_u32 s57, s3, 32
  s_mul_i32 s57, s57, 57
  s_lshr_b32 s57, s57, 9
  s_mul_i32 s57, s57, 138240
  s_add_u32 s57, s57, s55
  s_add_u32 s54, s57, 32768
  s_mul_i32 s58, s35, 12
  s_add_u32 s58, s58, s34
  s_lshl_b32 s58, s58, 7
  s_add_u32 s58, s58, 10223616
  s_waitcnt vmcnt(0) lgkmcnt(0)
  s_barrier
  s_add_u32 m0, s38, 0
  s_add_u32 s40, s37, 0
  buffer_load_dwordx4 v4, s[16:19], s40 offen lds
  s_add_u32 m0, s38, 1024
  s_add_u32 s40, s37, 0
  buffer_load_dwordx4 v5, s[16:19], s40 offen lds
  s_add_u32 m0, s38, 2048
  s_add_u32 s40, s37, 18432
  buffer_load_dwordx4 v4, s[16:19], s40 offen lds
  s_add_u32 m0, s38, 3072
  s_add_u32 s40, s37, 18432
  buffer_load_dwordx4 v5, s[16:19], s40 offen lds
  s_add_u32 m0, s38, 4096
  s_add_u32 s40, s37, 36864
  buffer_load_dwordx4 v4, s[16:19], s40 offen lds
  s_add_u32 m0, s38, 5120
  s_add_u32 s40, s37, 36864
  buffer_load_dwordx4 v5, s[16:19], s40 offen lds
  s_add_u32 m0, s38, 6144
  s_add_u32 s40, s37, 55296
  buffer_load_dwordx4 v4, s[16:19], s40 offen lds
  s_add_u32 m0, s38, 7168
  s_add_u32 s40, s37, 55296
  buffer_load_dwordx4 v5, s[16:19], s40 offen lds
  s_add_u32 m0, s38, 34816
  s_add_u32 s40, s37, 128
  buffer_load_dwordx4 v4, s[16:19], s40 offen lds
  s_add_u32 m0, s38, 35840
  s_add_u32 s40, s37, 128
  buffer_load_dwordx4 v5, s[16:19], s40 offen lds
  s_add_u32 m0, s38, 36864
  s_add_u32 s40, s37, 18560
  buffer_load_dwordx4 v4, s[16:19], s40 offen lds
  s_add_u32 m0, s38, 37888
  s_add_u32 s40, s37, 18560
  buffer_load_dwordx4 v5, s[16:19], s40 offen lds
  s_add_u32 m0, s38, 38912
  s_add_u32 s40, s37, 36992
  buffer_load_dwordx4 v4, s[16:19], s40 offen lds
  s_add_u32 m0, s38, 39936
  s_add_u32 s40, s37, 36992
  buffer_load_dwordx4 v5, s[16:19], s40 offen lds
  s_add_u32 m0, s38, 40960
  s_add_u32 s40, s37, 55424
  buffer_load_dwordx4 v4, s[16:19], s40 offen lds
  s_add_u32 m0, s38, 41984
  s_add_u32 s40, s37, 55424
  buffer_load_dwordx4 v5, s[16:19], s40 offen lds
  s_waitcnt vmcnt(8)
  s_barrier
  s_add_u32 m0, s38, 69632
  s_add_u32 s40, s37, 256
  buffer_load_dwordx4 v4, s[16:19], s40 offen lds
  s_add_u32 m0, s38, 70656
  s_add_u32 s40, s37, 256
  buffer_load_dwordx4 v5, s[16:19], s40 offen lds
  s_add_u32 m0, s38, 71680
  s_add_u32 s40, s37, 18688
  buffer_load_dwordx4 v4, s[16:19], s40 offen lds
  s_add_u32 m0, s38, 72704
  s_add_u32 s40, s37, 18688
  buffer_load_dwordx4 v5, s[16:19], s40 offen lds
  s_add_u32 m0, s38, 73728
  s_add_u32 s40, s37, 37120
  buffer_load_dwordx4 v4, s[16:19], s40 offen lds
  s_add_u32 m0, s38, 74752
  s_add_u32 s40, s37, 37120
  buffer_load_dwordx4 v5, s[16:19], s40 offen lds
  s_add_u32 m0, s38, 75776
  s_add_u32 s40, s37, 55552
  buffer_load_dwordx4 v4, s[16:19], s40 offen lds
  s_add_u32 m0, s38, 76800
  s_add_u32 s40, s37, 55552
  buffer_load_dwordx4 v5, s[16:19], s40 offen lds
  s_waitcnt vmcnt(8)
  s_barrier
  s_add_u32 m0, s38, 104448
  s_add_u32 s40, s37, 384
  buffer_load_dwordx4 v4, s[16:19], s40 offen lds
  s_add_u32 m0, s38, 105472
  s_add_u32 s40, s37, 384
  buffer_load_dwordx4 v5, s[16:19], s40 offen lds
  s_add_u32 m0, s38, 106496
  s_add_u32 s40, s37, 18816
  buffer_load_dwordx4 v4, s[16:19], s40 offen lds
  s_add_u32 m0, s38, 107520
  s_add_u32 s40, s37, 18816
  buffer_load_dwordx4 v5, s[16:19], s40 offen lds
  s_add_u32 m0, s38, 108544
  s_add_u32 s40, s37, 37248
  buffer_load_dwordx4 v4, s[16:19], s40 offen lds
  s_add_u32 m0, s38, 109568
  s_add_u32 s40, s37, 37248
  buffer_load_dwordx4 v5, s[16:19], s40 offen lds
  s_add_u32 m0, s38, 110592
  s_add_u32 s40, s37, 55680
  buffer_load_dwordx4 v4, s[16:19], s40 offen lds
  s_add_u32 m0, s38, 111616
  s_add_u32 s40, s37, 55680
  buffer_load_dwordx4 v5, s[16:19], s40 offen lds
  s_waitcnt vmcnt(8)
  s_barrier
  s_add_u32 m0, s38, 0
  s_add_u32 s40, s37, 512
  buffer_load_dwordx4 v4, s[16:19], s40 offen lds
  s_add_u32 m0, s38, 1024
  s_add_u32 s40, s37, 512
  buffer_load_dwordx4 v5, s[16:19], s40 offen lds
  s_add_u32 m0, s38, 2048
  s_add_u32 s40, s37, 18944
  buffer_load_dwordx4 v4, s[16:19], s40 offen lds
  s_add_u32 m0, s38, 3072
  s_add_u32 s40, s37, 18944
  buffer_load_dwordx4 v5, s[16:19], s40 offen lds
  s_add_u32 m0, s38, 4096
  s_add_u32 s40, s37, 37376
  buffer_load_dwordx4 v4, s[16:19], s40 offen lds
  s_add_u32 m0, s38, 5120
  s_add_u32 s40, s37, 37376
  buffer_load_dwordx4 v5, s[16:19], s40 offen lds
  s_add_u32 m0, s38, 6144
  s_add_u32 s40, s37, 55808
  buffer_load_dwordx4 v4, s[16:19], s40 offen lds
  s_add_u32 m0, s38, 7168
  s_add_u32 s40, s37, 55808
  buffer_load_dwordx4 v5, s[16:19], s40 offen lds
  s_waitcnt vmcnt(8)
  s_barrier
  s_add_u32 m0, s38, 34816
  s_add_u32 s40, s37, 640
  buffer_load_dwordx4 v4, s[16:19], s40 offen lds
  s_add_u32 m0, s38, 35840
  s_add_u32 s40, s37, 640
  buffer_load_dwordx4 v5, s[16:19], s40 offen lds
  s_add_u32 m0, s38, 36864
  s_add_u32 s40, s37, 19072
  buffer_load_dwordx4 v4, s[16:19], s40 offen lds
  s_add_u32 m0, s38, 37888
  s_add_u32 s40, s37, 19072
  buffer_load_dwordx4 v5, s[16:19], s40 offen lds
  s_add_u32 m0, s38, 38912
  s_add_u32 s40, s37, 37504
  buffer_load_dwordx4 v4, s[16:19], s40 offen lds
  s_add_u32 m0, s38, 39936
  s_add_u32 s40, s37, 37504
  buffer_load_dwordx4 v5, s[16:19], s40 offen lds
  s_add_u32 m0, s38, 40960
  s_add_u32 s40, s37, 55936
  buffer_load_dwordx4 v4, s[16:19], s40 offen lds
  s_add_u32 m0, s38, 41984
  s_add_u32 s40, s37, 55936
  buffer_load_dwordx4 v5, s[16:19], s40 offen lds
  s_waitcnt vmcnt(8)
  s_barrier
  s_add_u32 m0, s38, 69632
  s_add_u32 s40, s37, 768
  buffer_load_dwordx4 v4, s[16:19], s40 offen lds
  s_add_u32 m0, s38, 70656
  s_add_u32 s40, s37, 768
  buffer_load_dwordx4 v5, s[16:19], s40 offen lds
  s_add_u32 m0, s38, 71680
  s_add_u32 s40, s37, 19200
  buffer_load_dwordx4 v4, s[16:19], s40 offen lds
  s_add_u32 m0, s38, 72704
  s_add_u32 s40, s37, 19200
  buffer_load_dwordx4 v5, s[16:19], s40 offen lds
  s_add_u32 m0, s38, 73728
  s_add_u32 s40, s37, 37632
  buffer_load_dwordx4 v4, s[16:19], s40 offen lds
  s_add_u32 m0, s38, 74752
  s_add_u32 s40, s37, 37632
  buffer_load_dwordx4 v5, s[16:19], s40 offen lds
  s_add_u32 m0, s38, 75776
  s_add_u32 s40, s37, 56064
  buffer_load_dwordx4 v4, s[16:19], s40 offen lds
  s_add_u32 m0, s38, 76800
  s_add_u32 s40, s37, 56064
  buffer_load_dwordx4 v5, s[16:19], s40 offen lds
  s_waitcnt vmcnt(8)
  s_barrier
  s_add_u32 m0, s38, 104448
  s_add_u32 s40, s37, 896
  buffer_load_dwordx4 v4, s[16:19], s40 offen lds
  s_add_u32 m0, s38, 105472
  s_add_u32 s40, s37, 896
  buffer_load_dwordx4 v5, s[16:19], s40 offen lds
  s_add_u32 m0, s38, 106496
  s_add_u32 s40, s37, 19328
  buffer_load_dwordx4 v4, s[16:19], s40 offen lds
  s_add_u32 m0, s38, 107520
  s_add_u32 s40, s37, 19328
  buffer_load_dwordx4 v5, s[16:19], s40 offen lds
  s_add_u32 m0, s38, 108544
  s_add_u32 s40, s37, 37760
  buffer_load_dwordx4 v4, s[16:19], s40 offen lds
  s_add_u32 m0, s38, 109568
  s_add_u32 s40, s37, 37760
  buffer_load_dwordx4 v5, s[16:19], s40 offen lds
  s_add_u32 m0, s38, 110592
  s_add_u32 s40, s37, 56192
  buffer_load_dwordx4 v4, s[16:19], s40 offen lds
  s_add_u32 m0, s38, 111616
  s_add_u32 s40, s37, 56192
  buffer_load_dwordx4 v5, s[16:19], s40 offen lds
  s_waitcnt vmcnt(8)
  s_barrier
  s_add_u32 m0, s38, 0
  s_add_u32 s40, s37, 1024
  buffer_load_dwordx4 v4, s[16:19], s40 offen lds
  s_add_u32 m0, s38, 1024
  s_add_u32 s40, s37, 1024
  buffer_load_dwordx4 v5, s[16:19], s40 offen lds
  s_add_u32 m0, s38, 2048
  s_add_u32 s40, s37, 19456
  buffer_load_dwordx4 v4, s[16:19], s40 offen lds
  s_add_u32 m0, s38, 3072
  s_add_u32 s40, s37, 19456
  buffer_load_dwordx4 v5, s[16:19], s40 offen lds
  s_add_u32 m0, s38, 4096
  s_add_u32 s40, s37, 37888
  buffer_load_dwordx4 v4, s[16:19], s40 offen lds
  s_add_u32 m0, s38, 5120
  s_add_u32 s40, s37, 37888
  buffer_load_dwordx4 v5, s[16:19], s40 offen lds
  s_add_u32 m0, s38, 6144
  s_add_u32 s40, s37, 56320
  buffer_load_dwordx4 v4, s[16:19], s40 offen lds
  s_add_u32 m0, s38, 7168
  s_add_u32 s40, s37, 56320
  buffer_load_dwordx4 v5, s[16:19], s40 offen lds
  s_waitcnt vmcnt(8)
  s_barrier
  s_waitcnt vmcnt(0)
  s_barrier
  s_branch L_copy
L_ldw:
  s_movk_i32 s41, 3641
  v_add_u32 v1, 0, v0
  v_mul_u32_u24 v2, s41, v1
  v_lshrrev_b32 v2, 16, v2
  v_mul_u32_u24 v3, 18, v2
  v_sub_u32 v3, v1, v3
  v_bfe_u32 v1, v2, 2, 2
  v_lshlrev_b32 v1, 3, v1
  v_lshrrev_b32 v13, 4, v2
  v_lshl_add_u32 v1, v13, 2, v1
  v_and_b32 v2, 3, v2
  v_add_u32 v1, v1, v2
  v_mul_u32_u24 v1, 3456, v1
  v_lshl_add_u32 v4, v3, 4, v1
  v_add_u32 v1, 64, v0
  v_mul_u32_u24 v2, s41, v1
  v_lshrrev_b32 v2, 16, v2
  v_mul_u32_u24 v3, 18, v2
  v_sub_u32 v3, v1, v3
  v_bfe_u32 v1, v2, 2, 2
  v_lshlrev_b32 v1, 3, v1
  v_lshrrev_b32 v13, 4, v2
  v_lshl_add_u32 v1, v13, 2, v1
  v_and_b32 v2, 3, v2
  v_add_u32 v1, v1, v2
  v_mul_u32_u24 v1, 3456, v1
  v_lshl_add_u32 v5, v3, 4, v1
  v_add_u32 v1, 128, v0
  v_mul_u32_u24 v2, s41, v1
  v_lshrrev_b32 v2, 16, v2
  v_mul_u32_u24 v3, 18, v2
  v_sub_u32 v3, v1, v3
  v_bfe_u32 v1, v2, 2, 2
  v_lshlrev_b32 v1, 3, v1
  v_lshrrev_b32 v13, 4, v2
  v_lshl_add_u32 v1, v13, 2, v1
  v_and_b32 v2, 3, v2
  v_add_u32 v1, v1, v2
  v_mul_u32_u24 v1, 3456, v1
  v_lshl_add_u32 v6, v3, 4, v1
  s_waitcnt lgkmcnt(0)
  s_mov_b32 s64, 10371072
  s_load_dword s65, s[8:9], s64
  v_add_u32 v1, 192, v0
  v_mul_u32_u24 v2, s41, v1
  v_lshrrev_b32 v2, 16, v2
  v_mul_u32_u24 v3, 18, v2
  v_sub_u32 v3, v1, v3
  v_bfe_u32 v1, v2, 2, 2
  v_lshlrev_b32 v1, 3, v1
  v_lshrrev_b32 v13, 4, v2
  v_lshl_add_u32 v1, v13, 2, v1
  v_and_b32 v2, 3, v2
  v_add_u32 v1, v1, v2
  v_mul_u32_u24 v1, 3456, v1
  v_lshl_add_u32 v7, v3, 4, v1
  v_add_u32 v1, 256, v0
  v_mul_u32_u24 v2, s41, v1
  v_lshrrev_b32 v2, 16, v2
  v_mul_u32_u24 v3, 18, v2
  v_sub_u32 v3, v1, v3
  v_bfe_u32 v1, v2, 2, 2
  v_lshlrev_b32 v1, 3, v1
  v_lshrrev_b32 v13, 4, v2
  v_lshl_add_u32 v1, v13, 2, v1
  v_and_b32 v2, 3, v2
  v_add_u32 v1, v1, v2
  v_mul_u32_u24 v1, 3456, v1
  v_lshl_add_u32 v8, v3, 4, v1
  v_add_u32 v1, 320, v0
  v_mul_u32_u24 v2, s41, v1
  v_lshrrev_b32 v2, 16, v2
  v_mul_u32_u24 v3, 18, v2
  v_sub_u32 v3, v1, v3
  v_bfe_u32 v1, v2, 2, 2
  v_lshlrev_b32 v1, 3, v1
  v_lshrrev_b32 v13, 4, v2
  v_lshl_add_u32 v1, v13, 2, v1
  v_and_b32 v2, 3, v2
  v_add_u32 v1, v1, v2
  v_mul_u32_u24 v1, 3456, v1
  v_lshl_add_u32 v9, v3, 4, v1
  v_add_u32 v1, 384, v0
  v_mul_u32_u24 v2, s41, v1
  v_lshrrev_b32 v2, 16, v2
  v_mul_u32_u24 v3, 18, v2
  v_sub_u32 v3, v1, v3
  v_bfe_u32 v1, v2, 2, 2
  v_lshlrev_b32 v1, 3, v1
  v_lshrrev_b32 v13, 4, v2
  v_lshl_add_u32 v1, v13, 2, v1
  v_and_b32 v2, 3, v2
  v_add_u32 v1, v1, v2
  v_mul_u32_u24 v1, 3456, v1
  v_lshl_add_u32 v10, v3, 4, v1
  v_add_u32 v1, 448, v0
  v_mul_u32_u24 v2, s41, v1
  v_lshrrev_b32 v2, 16, v2
  v_mul_u32_u24 v3, 18, v2
  v_sub_u32 v3, v1, v3
  v_bfe_u32 v1, v2, 2, 2
  v_lshlrev_b32 v1, 3, v1
  v_lshrrev_b32 v13, 4, v2
  v_lshl_add_u32 v1, v13, 2, v1
  v_and_b32 v2, 3, v2
  v_add_u32 v1, v1, v2
  v_mul_u32_u24 v1, 3456, v1
  v_lshl_add_u32 v11, v3, 4, v1
  v_add_u32 v1, 512, v0
  v_mul_u32_u24 v2, s41, v1
  v_lshrrev_b32 v2, 16, v2
  v_mul_u32_u24 v3, 18, v2
  v_sub_u32 v3, v1, v3
  v_bfe_u32 v1, v2, 2, 2
  v_lshlrev_b32 v1, 3, v1
  v_lshrrev_b32 v13, 4, v2
  v_lshl_add_u32 v1, v13, 2, v1
  v_and_b32 v2, 3, v2
  v_add_u32 v1, v1, v2
  v_mul_u32_u24 v1, 3456, v1
  v_lshl_add_u32 v12, v3, 4, v1
  s_sub_u32 s36, s3, 6
  s_mul_i32 s37, s36, 110592
  s_mul_i32 s38, s36, 9216
  s_mul_i32 s39, s34, 288
  s_sub_u32 s42, 1990656, s39
  s_mul_i32 s55, s34, 589824
  s_mul_i32 s56, s35, 9216
  s_add_u32 s55, s55, s56
  s_lshl_b32 s56, s3, 10
  s_add_u32 s55, s55, s56
  s_add_u32 s57, s3, 0
  s_mul_i32 s57, s57, 57
  s_lshr_b32 s57, s57, 9
  s_mul_i32 s57, s57, 138240
  s_add_u32 s57, s57, s55
  s_add_u32 s50, s57, 0
  s_add_u32 s57, s3, 8
  s_mul_i32 s57, s57, 57
  s_lshr_b32 s57, s57, 9
  s_mul_i32 s57, s57, 138240
  s_add_u32 s57, s57, s55
  s_add_u32 s51, s57, 8192
  s_add_u32 s57, s3, 16
  s_mul_i32 s57, s57, 57
  s_lshr_b32 s57, s57, 9
  s_mul_i32 s57, s57, 138240
  s_add_u32 s57, s57, s55
  s_add_u32 s52, s57, 16384
  s_add_u32 s57, s3, 24
  s_mul_i32 s57, s57, 57
  s_lshr_b32 s57, s57, 9
  s_mul_i32 s57, s57, 138240
  s_add_u32 s57, s57, s55
  s_add_u32 s53, s57, 24576
  s_add_u32 s57, s3, 32
  s_mul_i32 s57, s57, 57
  s_lshr_b32 s57, s57, 9
  s_mul_i32 s57, s57, 138240
  s_add_u32 s57, s57, s55
  s_add_u32 s54, s57, 32768
  s_mul_i32 s58, s35, 12
  s_add_u32 s58, s58, s34
  s_lshl_b32 s58, s58, 7
  s_add_u32 s58, s58, 10223616
  s_add_u32 s16, s6, s39
  s_addc_u32 s17, s7, 0
  s_and_b32 s17, s17, 0xffff
  s_mov_b32 s18, s42
  s_mov_b32 s19, 0x20000
  s_waitcnt lgkmcnt(0)
  s_barrier
  s_add_u32 s40, s37, 0
  s_add_u32 m0, s38, 16384
  s_nop 0
  buffer_load_dwordx4 v4, s[16:19], s40 offen lds
  s_add_u32 m0, s38, 17408
  s_nop 0
  buffer_load_dwordx4 v5, s[16:19], s40 offen lds
  s_add_u32 m0, s38, 18432
  s_nop 0
  buffer_load_dwordx4 v6, s[16:19], s40 offen lds
  s_add_u32 m0, s38, 19456
  s_nop 0
  buffer_load_dwordx4 v7, s[16:19], s40 offen lds
  s_add_u32 m0, s38, 20480
  s_nop 0
  buffer_load_dwordx4 v8, s[16:19], s40 offen lds
  s_add_u32 m0, s38, 21504
  s_nop 0
  buffer_load_dwordx4 v9, s[16:19], s40 offen lds
  s_add_u32 m0, s38, 22528
  s_nop 0
  buffer_load_dwordx4 v10, s[16:19], s40 offen lds
  s_add_u32 m0, s38, 23552
  s_nop 0
  buffer_load_dwordx4 v11, s[16:19], s40 offen lds
  s_add_u32 m0, s38, 24576
  s_nop 0
  buffer_load_dwordx4 v12, s[16:19], s40 offen lds
  s_add_u32 s40, s37, 221184
  s_add_u32 m0, s38, 51200
  s_nop 0
  buffer_load_dwordx4 v4, s[16:19], s40 offen lds
  s_add_u32 m0, s38, 52224
  s_nop 0
  buffer_load_dwordx4 v5, s[16:19], s40 offen lds
  s_add_u32 m0, s38, 53248
  s_nop 0
  buffer_load_dwordx4 v6, s[16:19], s40 offen lds
  s_add_u32 m0, s38, 54272
  s_nop 0
  buffer_load_dwordx4 v7, s[16:19], s40 offen lds
  s_add_u32 m0, s38, 55296
  s_nop 0
  buffer_load_dwordx4 v8, s[16:19], s40 offen lds
  s_add_u32 m0, s38, 56320
  s_nop 0
  buffer_load_dwordx4 v9, s[16:19], s40 offen lds
  s_add_u32 m0, s38, 57344
  s_nop 0
  buffer_load_dwordx4 v10, s[16:19], s40 offen lds
  s_add_u32 m0, s38, 58368
  s_nop 0
  buffer_load_dwordx4 v11, s[16:19], s40 offen lds
  s_add_u32 m0, s38, 59392
  s_nop 0
  buffer_load_dwordx4 v12, s[16:19], s40 offen lds
  s_waitcnt vmcnt(9)
  s_barrier
  s_add_u32 s40, s37, 442368
  s_add_u32 m0, s38, 86016
  s_nop 0
  buffer_load_dwordx4 v4, s[16:19], s40 offen lds
  s_add_u32 m0, s38, 87040
  s_nop 0
  buffer_load_dwordx4 v5, s[16:19], s40 offen lds
  s_add_u32 m0, s38, 88064
  s_nop 0
  buffer_load_dwordx4 v6, s[16:19], s40 offen lds
  s_add_u32 m0, s38, 89088
  s_nop 0
  buffer_load_dwordx4 v7, s[16:19], s40 offen lds
  s_add_u32 m0, s38, 90112
  s_nop 0
  buffer_load_dwordx4 v8, s[16:19], s40 offen lds
  s_add_u32 m0, s38, 91136
  s_nop 0
  buffer_load_dwordx4 v9, s[16:19], s40 offen lds
  s_add_u32 m0, s38, 92160
  s_nop 0
  buffer_load_dwordx4 v10, s[16:19], s40 offen lds
  s_add_u32 m0, s38, 93184
  s_nop 0
  buffer_load_dwordx4 v11, s[16:19], s40 offen lds
  s_add_u32 m0, s38, 94208
  s_nop 0
  buffer_load_dwordx4 v12, s[16:19], s40 offen lds
  s_waitcnt vmcnt(9)
  s_barrier
  s_add_u32 s40, s37, 663552
  s_add_u32 m0, s38, 120832
  s_nop 0
  buffer_load_dwordx4 v4, s[16:19], s40 offen lds
  s_add_u32 m0, s38, 121856
  s_nop 0
  buffer_load_dwordx4 v5, s[16:19], s40 offen lds
  s_add_u32 m0, s38, 122880
  s_nop 0
  buffer_load_dwordx4 v6, s[16:19], s40 offen lds
  s_add_u32 m0, s38, 123904
  s_nop 0
  buffer_load_dwordx4 v7, s[16:19], s40 offen lds
  s_add_u32 m0, s38, 124928
  s_nop 0
  buffer_load_dwordx4 v8, s[16:19], s40 offen lds
  s_add_u32 m0, s38, 125952
  s_nop 0
  buffer_load_dwordx4 v9, s[16:19], s40 offen lds
  s_add_u32 m0, s38, 126976
  s_nop 0
  buffer_load_dwordx4 v10, s[16:19], s40 offen lds
  s_add_u32 m0, s38, 128000
  s_nop 0
  buffer_load_dwordx4 v11, s[16:19], s40 offen lds
  s_add_u32 m0, s38, 129024
  s_nop 0
  buffer_load_dwordx4 v12, s[16:19], s40 offen lds
  s_waitcnt vmcnt(9)
  s_barrier
  s_add_u32 s40, s37, 884736
  s_add_u32 m0, s38, 16384
  s_nop 0
  buffer_load_dwordx4 v4, s[16:19], s40 offen lds
  s_add_u32 m0, s38, 17408
  s_nop 0
  buffer_load_dwordx4 v5, s[16:19], s40 offen lds
  s_add_u32 m0, s38, 18432
  s_nop 0
  buffer_load_dwordx4 v6, s[16:19], s40 offen lds
  s_add_u32 m0, s38, 19456
  s_nop 0
  buffer_load_dwordx4 v7, s[16:19], s40 offen lds
  s_add_u32 m0, s38, 20480
  s_nop 0
  buffer_load_dwordx4 v8, s[16:19], s40 offen lds
  s_add_u32 m0, s38, 21504
  s_nop 0
  buffer_load_dwordx4 v9, s[16:19], s40 offen lds
  s_add_u32 m0, s38, 22528
  s_nop 0
  buffer_load_dwordx4 v10, s[16:19], s40 offen lds
  s_add_u32 m0, s38, 23552
  s_nop 0
  buffer_load_dwordx4 v11, s[16:19], s40 offen lds
  s_add_u32 m0, s38, 24576
  s_nop 0
  buffer_load_dwordx4 v12, s[16:19], s40 offen lds
  s_waitcnt vmcnt(9)
  s_barrier
  s_add_u32 s40, s37, 1105920
  s_add_u32 m0, s38, 51200
  s_nop 0
  buffer_load_dwordx4 v4, s[16:19], s40 offen lds
  s_add_u32 m0, s38, 52224
  s_nop 0
  buffer_load_dwordx4 v5, s[16:19], s40 offen lds
  s_add_u32 m0, s38, 53248
  s_nop 0
  buffer_load_dwordx4 v6, s[16:19], s40 offen lds
  s_add_u32 m0, s38, 54272
  s_nop 0
  buffer_load_dwordx4 v7, s[16:19], s40 offen lds
  s_add_u32 m0, s38, 55296
  s_nop 0
  buffer_load_dwordx4 v8, s[16:19], s40 offen lds
  s_add_u32 m0, s38, 56320
  s_nop 0
  buffer_load_dwordx4 v9, s[16:19], s40 offen lds
  s_add_u32 m0, s38, 57344
  s_nop 0
  buffer_load_dwordx4 v10, s[16:19], s40 offen lds
  s_add_u32 m0, s38, 58368
  s_nop 0
  buffer_load_dwordx4 v11, s[16:19], s40 offen lds
  s_add_u32 m0, s38, 59392
  s_nop 0
  buffer_load_dwordx4 v12, s[16:19], s40 offen lds
  s_waitcnt vmcnt(9)
  s_barrier
  s_add_u32 s40, s37, 1327104
  s_add_u32 m0, s38, 86016
  s_nop 0
  buffer_load_dwordx4 v4, s[16:19], s40 offen lds
  s_add_u32 m0, s38, 87040
  s_nop 0
  buffer_load_dwordx4 v5, s[16:19], s40 offen lds
  s_add_u32 m0, s38, 88064
  s_nop 0
  buffer_load_dwordx4 v6, s[16:19], s40 offen lds
  s_add_u32 m0, s38, 89088
  s_nop 0
  buffer_load_dwordx4 v7, s[16:19], s40 offen lds
  s_add_u32 m0, s38, 90112
  s_nop 0
  buffer_load_dwordx4 v8, s[16:19], s40 offen lds
  s_add_u32 m0, s38, 91136
  s_nop 0
  buffer_load_dwordx4 v9, s[16:19], s40 offen lds
  s_add_u32 m0, s38, 92160
  s_nop 0
  buffer_load_dwordx4 v10, s[16:19], s40 offen lds
  s_add_u32 m0, s38, 93184
  s_nop 0
  buffer_load_dwordx4 v11, s[16:19], s40 offen lds
  s_add_u32 m0, s38, 94208
  s_nop 0
  buffer_load_dwordx4 v12, s[16:19], s40 offen lds
  s_waitcnt vmcnt(9)
  s_barrier
  s_add_u32 s40, s37, 1548288
  s_add_u32 m0, s38, 120832
  s_nop 0
  buffer_load_dwordx4 v4, s[16:19], s40 offen lds
  s_add_u32 m0, s38, 121856
  s_nop 0
  buffer_load_dwordx4 v5, s[16:19], s40 offen lds
  s_add_u32 m0, s38, 122880
  s_nop 0
  buffer_load_dwordx4 v6, s[16:19], s40 offen lds
  s_add_u32 m0, s38, 123904
  s_nop 0
  buffer_load_dwordx4 v7, s[16:19], s40 offen lds
  s_add_u32 m0, s38, 124928
  s_nop 0
  buffer_load_dwordx4 v8, s[16:19], s40 offen lds
  s_add_u32 m0, s38, 125952
  s_nop 0
  buffer_load_dwordx4 v9, s[16:19], s40 offen lds
  s_add_u32 m0, s38, 126976
  s_nop 0
  buffer_load_dwordx4 v10, s[16:19], s40 offen lds
  s_add_u32 m0, s38, 128000
  s_nop 0
  buffer_load_dwordx4 v11, s[16:19], s40 offen lds
  s_add_u32 m0, s38, 129024
  s_nop 0
  buffer_load_dwordx4 v12, s[16:19], s40 offen lds
  s_waitcnt vmcnt(9)
  s_barrier
  s_add_u32 s40, s37, 1769472
  s_add_u32 m0, s38, 16384
  s_nop 0
  buffer_load_dwordx4 v4, s[16:19], s40 offen lds
  s_add_u32 m0, s38, 17408
  s_nop 0
  buffer_load_dwordx4 v5, s[16:19], s40 offen lds
  s_add_u32 m0, s38, 18432
  s_nop 0
  buffer_load_dwordx4 v6, s[16:19], s40 offen lds
  s_add_u32 m0, s38, 19456
  s_nop 0
  buffer_load_dwordx4 v7, s[16:19], s40 offen lds
  s_add_u32 m0, s38, 20480
  s_nop 0
  buffer_load_dwordx4 v8, s[16:19], s40 offen lds
  s_add_u32 m0, s38, 21504
  s_nop 0
  buffer_load_dwordx4 v9, s[16:19], s40 offen lds
  s_add_u32 m0, s38, 22528
  s_nop 0
  buffer_load_dwordx4 v10, s[16:19], s40 offen lds
  s_add_u32 m0, s38, 23552
  s_nop 0
  buffer_load_dwordx4 v11, s[16:19], s40 offen lds
  s_add_u32 m0, s38, 24576
  s_nop 0
  buffer_load_dwordx4 v12, s[16:19], s40 offen lds
  s_waitcnt vmcnt(9)
  s_barrier
  s_waitcnt vmcnt(0)
  s_barrier
  s_branch L_copy
L_comp:
  v_and_b32 v8, 15, v0
  v_lshrrev_b32 v9, 4, v0
  v_lshrrev_b32 v10, 1, v8
  v_xor_b32 v10, v10, v9
  s_lshl_b32 s36, s3, 12
  v_lshlrev_b32 v2, 7, v8
  v_lshl_add_u32 v2, v10, 4, v2
  v_add_u32 v2, s36, v2
  v_xor_b32 v3, 64, v2
  v_add_u32 v4, 69632, v2
  v_add_u32 v5, 69632, v3
  v_lshrrev_b32 v10, 2, v0
  v_mul_u32_u24 v6, 288, v10
  v_and_b32 v10, 3, v0
  v_lshl_add_u32 v6, v10, 3, v6
  v_add_u32 v6, 16384, v6
  v_add_u32 v7, 69632, v6
  s_waitcnt lgkmcnt(0)
  s_mov_b32 s64, 10371072
  s_load_dword s65, s[8:9], s64
  s_mov_b32 s36, 1.0
  s_cmp_lt_u32 s34, 4
  s_cselect_b32 s36, 0x3eae1a93, s36
  s_mov_b32 s37, s36
  s_lshl_b32 s38, s3, 5
  v_add_u32 v10, s38, v8
  v_mul_u32_u24 v10, 72, v10
  v_lshl_add_u32 v10, v9, 3, v10
  v_add_u32 v10, 34816, v10
  v_add_u32 v11, 0, v9
  v_mul_u32_u24 v11, 57, v11
  v_lshrrev_b32 v11, 9, v11
  v_mul_u32_u24 v11, 9144, v11
  v_add_u32 v12, v11, v10
  v_add_u32 v11, 4, v9
  v_mul_u32_u24 v11, 57, v11
  v_lshrrev_b32 v11, 9, v11
  v_mul_u32_u24 v11, 9144, v11
  v_add_u32 v13, v11, v10
  v_add_u32 v11, 8, v9
  v_mul_u32_u24 v11, 57, v11
  v_lshrrev_b32 v11, 9, v11
  v_mul_u32_u24 v11, 9144, v11
  v_add_u32 v14, v11, v10
  v_add_u32 v11, 12, v9
  v_mul_u32_u24 v11, 57, v11
  v_lshrrev_b32 v11, 9, v11
  v_mul_u32_u24 v11, 9144, v11
  v_add_u32 v15, v11, v10
  v_add_u32 v11, 16, v9
  v_mul_u32_u24 v11, 57, v11
  v_lshrrev_b32 v11, 9, v11
  v_mul_u32_u24 v11, 9144, v11
  v_add_u32 v16, v11, v10
  v_add_u32 v11, 20, v9
  v_mul_u32_u24 v11, 57, v11
  v_lshrrev_b32 v11, 9, v11
  v_mul_u32_u24 v11, 9144, v11
  v_add_u32 v17, v11, v10
  v_add_u32 v11, 24, v9
  v_mul_u32_u24 v11, 57, v11
  v_lshrrev_b32 v11, 9, v11
  v_mul_u32_u24 v11, 9144, v11
  v_add_u32 v18, v11, v10
  v_add_u32 v11, 28, v9
  v_mul_u32_u24 v11, 57, v11
  v_lshrrev_b32 v11, 9, v11
  v_mul_u32_u24 v11, 9144, v11
  v_add_u32 v19, v11, v10
  v_add_u32 v11, 32, v9
  v_mul_u32_u24 v11, 57, v11
  v_lshrrev_b32 v11, 9, v11
  v_mul_u32_u24 v11, 9144, v11
  v_add_u32 v20, v11, v10
  s_mul_i32 s55, s34, 589824
  s_mul_i32 s56, s35, 9216
  s_add_u32 s55, s55, s56
  s_lshl_b32 s56, s3, 10
  s_add_u32 s55, s55, s56
  s_add_u32 s57, s3, 0
  s_mul_i32 s57, s57, 57
  s_lshr_b32 s57, s57, 9
  s_mul_i32 s57, s57, 138240
  s_add_u32 s57, s57, s55
  s_add_u32 s50, s57, 0
  s_add_u32 s57, s3, 8
  s_mul_i32 s57, s57, 57
  s_lshr_b32 s57, s57, 9
  s_mul_i32 s57, s57, 138240
  s_add_u32 s57, s57, s55
  s_add_u32 s51, s57, 8192
  s_add_u32 s57, s3, 16
  s_mul_i32 s57, s57, 57
  s_lshr_b32 s57, s57, 9
  s_mul_i32 s57, s57, 138240
  s_add_u32 s57, s57, s55
  s_add_u32 s52, s57, 16384
  s_add_u32 s57, s3, 24
  s_mul_i32 s57, s57, 57
  s_lshr_b32 s57, s57, 9
  s_mul_i32 s57, s57, 138240
  s_add_u32 s57, s57, s55
  s_add_u32 s53, s57, 24576
  s_add_u32 s57, s3, 32
  s_mul_i32 s57, s57, 57
  s_lshr_b32 s57, s57, 9
  s_mul_i32 s57, s57, 138240
  s_add_u32 s57, s57, s55
  s_add_u32 s54, s57, 32768
  s_mul_i32 s58, s35, 12
  s_add_u32 s58, s58, s34
  s_lshl_b32 s58, s58, 7
  s_add_u32 s58, s58, 10223616
  s_waitcnt lgkmcnt(0)
  s_barrier
  s_barrier
  ds_read_b128 v[136:139], v2 offset:0
  ds_read_b128 v[140:143], v2 offset:2048
  ds_read_b64_tr_b16 v[24:25], v6 offset:0
  ds_read_b64_tr_b16 v[26:27], v6 offset:4608
  ds_read_b64_tr_b16 v[28:29], v6 offset:32
  ds_read_b64_tr_b16 v[30:31], v6 offset:4640
  ds_read_b64_tr_b16 v[32:33], v6 offset:64
  ds_read_b64_tr_b16 v[34:35], v6 offset:4672
  ds_read_b64_tr_b16 v[36:37], v6 offset:96
  ds_read_b64_tr_b16 v[38:39], v6 offset:4704
  ds_read_b64_tr_b16 v[40:41], v6 offset:128
  ds_read_b64_tr_b16 v[42:43], v6 offset:4736
  ds_read_b64_tr_b16 v[44:45], v6 offset:160
  ds_read_b64_tr_b16 v[46:47], v6 offset:4768
  ds_read_b64_tr_b16 v[48:49], v6 offset:192
  ds_read_b64_tr_b16 v[50:51], v6 offset:4800
  ds_read_b64_tr_b16 v[52:53], v6 offset:224
  ds_read_b64_tr_b16 v[54:55], v6 offset:4832
  ds_read_b64_tr_b16 v[56:57], v6 offset:256
  ds_read_b64_tr_b16 v[58:59], v6 offset:4864
  s_waitcnt lgkmcnt(15)
  v_mfma_f32_16x16x32_bf16 v[64:67], v[24:27], v[136:139], 0
  ds_read_b128 v[144:147], v3 offset:0
  ds_read_b128 v[148:151], v3 offset:2048
  v_mfma_f32_16x16x32_bf16 v[68:71], v[24:27], v[140:143], 0
  ds_read_b64_tr_b16 v[24:25], v6 offset:9216
  ds_read_b64_tr_b16 v[26:27], v6 offset:13824
  s_waitcnt lgkmcnt(15)
  v_mfma_f32_16x16x32_bf16 v[72:75], v[28:31], v[136:139], 0
  v_mfma_f32_16x16x32_bf16 v[76:79], v[28:31], v[140:143], 0
  ds_read_b64_tr_b16 v[28:29], v6 offset:9248
  ds_read_b64_tr_b16 v[30:31], v6 offset:13856
  s_waitcnt lgkmcnt(15)
  v_mfma_f32_16x16x32_bf16 v[80:83], v[32:35], v[136:139], 0
  v_mfma_f32_16x16x32_bf16 v[84:87], v[32:35], v[140:143], 0
  ds_read_b64_tr_b16 v[32:33], v6 offset:9280
  ds_read_b64_tr_b16 v[34:35], v6 offset:13888
  s_waitcnt lgkmcnt(15)
  v_mfma_f32_16x16x32_bf16 v[88:91], v[36:39], v[136:139], 0
  v_mfma_f32_16x16x32_bf16 v[92:95], v[36:39], v[140:143], 0
  ds_read_b64_tr_b16 v[36:37], v6 offset:9312
  ds_read_b64_tr_b16 v[38:39], v6 offset:13920
  s_waitcnt lgkmcnt(15)
  v_mfma_f32_16x16x32_bf16 v[96:99], v[40:43], v[136:139], 0
  v_mfma_f32_16x16x32_bf16 v[100:103], v[40:43], v[140:143], 0
  ds_read_b64_tr_b16 v[40:41], v6 offset:9344
  ds_read_b64_tr_b16 v[42:43], v6 offset:13952
  s_waitcnt lgkmcnt(15)
  v_mfma_f32_16x16x32_bf16 v[104:107], v[44:47], v[136:139], 0
  v_mfma_f32_16x16x32_bf16 v[108:111], v[44:47], v[140:143], 0
  ds_read_b64_tr_b16 v[44:45], v6 offset:9376
  ds_read_b64_tr_b16 v[46:47], v6 offset:13984
  s_waitcnt lgkmcnt(15)
  v_mfma_f32_16x16x32_bf16 v[112:115], v[48:51], v[136:139], 0
  v_mfma_f32_16x16x32_bf16 v[116:119], v[48:51], v[140:143], 0
  ds_read_b64_tr_b16 v[48:49], v6 offset:9408
  ds_read_b64_tr_b16 v[50:51], v6 offset:14016
  s_waitcnt lgkmcnt(15)
  v_mfma_f32_16x16x32_bf16 v[120:123], v[52:55], v[136:139], 0
  v_mfma_f32_16x16x32_bf16 v[124:127], v[52:55], v[140:143], 0
  ds_read_b64_tr_b16 v[52:53], v6 offset:9440
  ds_read_b64_tr_b16 v[54:55], v6 offset:14048
  s_waitcnt lgkmcnt(15)
  v_mfma_f32_16x16x32_bf16 v[128:131], v[56:59], v[136:139], 0
  v_mfma_f32_16x16x32_bf16 v[132:135], v[56:59], v[140:143], 0
  ds_read_b64_tr_b16 v[56:57], v6 offset:9472
  ds_read_b64_tr_b16 v[58:59], v6 offset:14080
  s_barrier
  s_waitcnt lgkmcnt(15)
  v_mfma_f32_16x16x32_bf16 v[64:67], v[24:27], v[144:147], v[64:67]
  ds_read_b128 v[136:139], v2 offset:34816
  ds_read_b128 v[140:143], v2 offset:36864
  v_mfma_f32_16x16x32_bf16 v[68:71], v[24:27], v[148:151], v[68:71]
  ds_read_b64_tr_b16 v[24:25], v6 offset:34816
  ds_read_b64_tr_b16 v[26:27], v6 offset:39424
  s_waitcnt lgkmcnt(15)
  v_mfma_f32_16x16x32_bf16 v[72:75], v[28:31], v[144:147], v[72:75]
  v_mfma_f32_16x16x32_bf16 v[76:79], v[28:31], v[148:151], v[76:79]
  ds_read_b64_tr_b16 v[28:29], v6 offset:34848
  ds_read_b64_tr_b16 v[30:31], v6 offset:39456
  s_waitcnt lgkmcnt(15)
  v_mfma_f32_16x16x32_bf16 v[80:83], v[32:35], v[144:147], v[80:83]
  v_mfma_f32_16x16x32_bf16 v[84:87], v[32:35], v[148:151], v[84:87]
  ds_read_b64_tr_b16 v[32:33], v6 offset:34880
  ds_read_b64_tr_b16 v[34:35], v6 offset:39488
  s_waitcnt lgkmcnt(15)
  v_mfma_f32_16x16x32_bf16 v[88:91], v[36:39], v[144:147], v[88:91]
  v_mfma_f32_16x16x32_bf16 v[92:95], v[36:39], v[148:151], v[92:95]
  ds_read_b64_tr_b16 v[36:37], v6 offset:34912
  ds_read_b64_tr_b16 v[38:39], v6 offset:39520
  s_waitcnt lgkmcnt(15)
  v_mfma_f32_16x16x32_bf16 v[96:99], v[40:43], v[144:147], v[96:99]
  v_mfma_f32_16x16x32_bf16 v[100:103], v[40:43], v[148:151], v[100:103]
  ds_read_b64_tr_b16 v[40:41], v6 offset:34944
  ds_read_b64_tr_b16 v[42:43], v6 offset:39552
  s_waitcnt lgkmcnt(15)
  v_mfma_f32_16x16x32_bf16 v[104:107], v[44:47], v[144:147], v[104:107]
  v_mfma_f32_16x16x32_bf16 v[108:111], v[44:47], v[148:151], v[108:111]
  ds_read_b64_tr_b16 v[44:45], v6 offset:34976
  ds_read_b64_tr_b16 v[46:47], v6 offset:39584
  s_waitcnt lgkmcnt(15)
  v_mfma_f32_16x16x32_bf16 v[112:115], v[48:51], v[144:147], v[112:115]
  v_mfma_f32_16x16x32_bf16 v[116:119], v[48:51], v[148:151], v[116:119]
  ds_read_b64_tr_b16 v[48:49], v6 offset:35008
  ds_read_b64_tr_b16 v[50:51], v6 offset:39616
  s_waitcnt lgkmcnt(15)
  v_mfma_f32_16x16x32_bf16 v[120:123], v[52:55], v[144:147], v[120:123]
  v_mfma_f32_16x16x32_bf16 v[124:127], v[52:55], v[148:151], v[124:127]
  ds_read_b64_tr_b16 v[52:53], v6 offset:35040
  ds_read_b64_tr_b16 v[54:55], v6 offset:39648
  s_waitcnt lgkmcnt(15)
  v_mfma_f32_16x16x32_bf16 v[128:131], v[56:59], v[144:147], v[128:131]
  v_mfma_f32_16x16x32_bf16 v[132:135], v[56:59], v[148:151], v[132:135]
  ds_read_b64_tr_b16 v[56:57], v6 offset:35072
  ds_read_b64_tr_b16 v[58:59], v6 offset:39680
  s_waitcnt lgkmcnt(15)
  v_mfma_f32_16x16x32_bf16 v[64:67], v[24:27], v[136:139], v[64:67]
  ds_read_b128 v[144:147], v3 offset:34816
  ds_read_b128 v[148:151], v3 offset:36864
  v_mfma_f32_16x16x32_bf16 v[68:71], v[24:27], v[140:143], v[68:71]
  ds_read_b64_tr_b16 v[24:25], v6 offset:44032
  ds_read_b64_tr_b16 v[26:27], v6 offset:48640
  s_waitcnt lgkmcnt(15)
  v_mfma_f32_16x16x32_bf16 v[72:75], v[28:31], v[136:139], v[72:75]
  v_mfma_f32_16x16x32_bf16 v[76:79], v[28:31], v[140:143], v[76:79]
  ds_read_b64_tr_b16 v[28:29], v6 offset:44064
  ds_read_b64_tr_b16 v[30:31], v6 offset:48672
  s_waitcnt lgkmcnt(15)
  v_mfma_f32_16x16x32_bf16 v[80:83], v[32:35], v[136:139], v[80:83]
  v_mfma_f32_16x16x32_bf16 v[84:87], v[32:35], v[140:143], v[84:87]
  ds_read_b64_tr_b16 v[32:33], v6 offset:44096
  ds_read_b64_tr_b16 v[34:35], v6 offset:48704
  s_waitcnt lgkmcnt(15)
  v_mfma_f32_16x16x32_bf16 v[88:91], v[36:39], v[136:139], v[88:91]
  v_mfma_f32_16x16x32_bf16 v[92:95], v[36:39], v[140:143], v[92:95]
  ds_read_b64_tr_b16 v[36:37], v6 offset:44128
  ds_read_b64_tr_b16 v[38:39], v6 offset:48736
  s_waitcnt lgkmcnt(15)
  v_mfma_f32_16x16x32_bf16 v[96:99], v[40:43], v[136:139], v[96:99]
  v_mfma_f32_16x16x32_bf16 v[100:103], v[40:43], v[140:143], v[100:103]
  ds_read_b64_tr_b16 v[40:41], v6 offset:44160
  ds_read_b64_tr_b16 v[42:43], v6 offset:48768
  s_waitcnt lgkmcnt(15)
  v_mfma_f32_16x16x32_bf16 v[104:107], v[44:47], v[136:139], v[104:107]
  v_mfma_f32_16x16x32_bf16 v[108:111], v[44:47], v[140:143], v[108:111]
  ds_read_b64_tr_b16 v[44:45], v6 offset:44192
  ds_read_b64_tr_b16 v[46:47], v6 offset:48800
  s_waitcnt lgkmcnt(15)
  v_mfma_f32_16x16x32_bf16 v[112:115], v[48:51], v[136:139], v[112:115]
  v_mfma_f32_16x16x32_bf16 v[116:119], v[48:51], v[140:143], v[116:119]
  ds_read_b64_tr_b16 v[48:49], v6 offset:44224
  ds_read_b64_tr_b16 v[50:51], v6 offset:48832
  s_waitcnt lgkmcnt(15)
  v_mfma_f32_16x16x32_bf16 v[120:123], v[52:55], v[136:139], v[120:123]
  v_mfma_f32_16x16x32_bf16 v[124:127], v[52:55], v[140:143], v[124:127]
  ds_read_b64_tr_b16 v[52:53], v6 offset:44256
  ds_read_b64_tr_b16 v[54:55], v6 offset:48864
  s_waitcnt lgkmcnt(15)
  v_mfma_f32_16x16x32_bf16 v[128:131], v[56:59], v[136:139], v[128:131]
  v_mfma_f32_16x16x32_bf16 v[132:135], v[56:59], v[140:143], v[132:135]
  ds_read_b64_tr_b16 v[56:57], v6 offset:44288
  ds_read_b64_tr_b16 v[58:59], v6 offset:48896
  s_barrier
  s_waitcnt lgkmcnt(15)
  v_mfma_f32_16x16x32_bf16 v[64:67], v[24:27], v[144:147], v[64:67]
  ds_read_b128 v[136:139], v4 offset:0
  ds_read_b128 v[140:143], v4 offset:2048
  v_mfma_f32_16x16x32_bf16 v[68:71], v[24:27], v[148:151], v[68:71]
  ds_read_b64_tr_b16 v[24:25], v7 offset:0
  ds_read_b64_tr_b16 v[26:27], v7 offset:4608
  s_waitcnt lgkmcnt(15)
  v_mfma_f32_16x16x32_bf16 v[72:75], v[28:31], v[144:147], v[72:75]
  v_mfma_f32_16x16x32_bf16 v[76:79], v[28:31], v[148:151], v[76:79]
  ds_read_b64_tr_b16 v[28:29], v7 offset:32
  ds_read_b64_tr_b16 v[30:31], v7 offset:4640
  s_waitcnt lgkmcnt(15)
  v_mfma_f32_16x16x32_bf16 v[80:83], v[32:35], v[144:147], v[80:83]
  v_mfma_f32_16x16x32_bf16 v[84:87], v[32:35], v[148:151], v[84:87]
  ds_read_b64_tr_b16 v[32:33], v7 offset:64
  ds_read_b64_tr_b16 v[34:35], v7 offset:4672
  s_waitcnt lgkmcnt(15)
  v_mfma_f32_16x16x32_bf16 v[88:91], v[36:39], v[144:147], v[88:91]
  v_mfma_f32_16x16x32_bf16 v[92:95], v[36:39], v[148:151], v[92:95]
  ds_read_b64_tr_b16 v[36:37], v7 offset:96
  ds_read_b64_tr_b16 v[38:39], v7 offset:4704
  s_waitcnt lgkmcnt(15)
  v_mfma_f32_16x16x32_bf16 v[96:99], v[40:43], v[144:147], v[96:99]
  v_mfma_f32_16x16x32_bf16 v[100:103], v[40:43], v[148:151], v[100:103]
  ds_read_b64_tr_b16 v[40:41], v7 offset:128
  ds_read_b64_tr_b16 v[42:43], v7 offset:4736
  s_waitcnt lgkmcnt(15)
  v_mfma_f32_16x16x32_bf16 v[104:107], v[44:47], v[144:147], v[104:107]
  v_mfma_f32_16x16x32_bf16 v[108:111], v[44:47], v[148:151], v[108:111]
  ds_read_b64_tr_b16 v[44:45], v7 offset:160
  ds_read_b64_tr_b16 v[46:47], v7 offset:4768
  s_waitcnt lgkmcnt(15)
  v_mfma_f32_16x16x32_bf16 v[112:115], v[48:51], v[144:147], v[112:115]
  v_mfma_f32_16x16x32_bf16 v[116:119], v[48:51], v[148:151], v[116:119]
  ds_read_b64_tr_b16 v[48:49], v7 offset:192
  ds_read_b64_tr_b16 v[50:51], v7 offset:4800
  s_waitcnt lgkmcnt(15)
  v_mfma_f32_16x16x32_bf16 v[120:123], v[52:55], v[144:147], v[120:123]
  v_mfma_f32_16x16x32_bf16 v[124:127], v[52:55], v[148:151], v[124:127]
  ds_read_b64_tr_b16 v[52:53], v7 offset:224
  ds_read_b64_tr_b16 v[54:55], v7 offset:4832
  s_waitcnt lgkmcnt(15)
  v_mfma_f32_16x16x32_bf16 v[128:131], v[56:59], v[144:147], v[128:131]
  v_mfma_f32_16x16x32_bf16 v[132:135], v[56:59], v[148:151], v[132:135]
  ds_read_b64_tr_b16 v[56:57], v7 offset:256
  ds_read_b64_tr_b16 v[58:59], v7 offset:4864
  s_waitcnt lgkmcnt(15)
  v_mfma_f32_16x16x32_bf16 v[64:67], v[24:27], v[136:139], v[64:67]
  ds_read_b128 v[144:147], v5 offset:0
  ds_read_b128 v[148:151], v5 offset:2048
  v_mfma_f32_16x16x32_bf16 v[68:71], v[24:27], v[140:143], v[68:71]
  ds_read_b64_tr_b16 v[24:25], v7 offset:9216
  ds_read_b64_tr_b16 v[26:27], v7 offset:13824
  s_waitcnt lgkmcnt(15)
  v_mfma_f32_16x16x32_bf16 v[72:75], v[28:31], v[136:139], v[72:75]
  v_mfma_f32_16x16x32_bf16 v[76:79], v[28:31], v[140:143], v[76:79]
  ds_read_b64_tr_b16 v[28:29], v7 offset:9248
  ds_read_b64_tr_b16 v[30:31], v7 offset:13856
  s_waitcnt lgkmcnt(15)
  v_mfma_f32_16x16x32_bf16 v[80:83], v[32:35], v[136:139], v[80:83]
  v_mfma_f32_16x16x32_bf16 v[84:87], v[32:35], v[140:143], v[84:87]
  ds_read_b64_tr_b16 v[32:33], v7 offset:9280
  ds_read_b64_tr_b16 v[34:35], v7 offset:13888
  s_waitcnt lgkmcnt(15)
  v_mfma_f32_16x16x32_bf16 v[88:91], v[36:39], v[136:139], v[88:91]
  v_mfma_f32_16x16x32_bf16 v[92:95], v[36:39], v[140:143], v[92:95]
  ds_read_b64_tr_b16 v[36:37], v7 offset:9312
  ds_read_b64_tr_b16 v[38:39], v7 offset:13920
  s_waitcnt lgkmcnt(15)
  v_mfma_f32_16x16x32_bf16 v[96:99], v[40:43], v[136:139], v[96:99]
  v_mfma_f32_16x16x32_bf16 v[100:103], v[40:43], v[140:143], v[100:103]
  ds_read_b64_tr_b16 v[40:41], v7 offset:9344
  ds_read_b64_tr_b16 v[42:43], v7 offset:13952
  s_waitcnt lgkmcnt(15)
  v_mfma_f32_16x16x32_bf16 v[104:107], v[44:47], v[136:139], v[104:107]
  v_mfma_f32_16x16x32_bf16 v[108:111], v[44:47], v[140:143], v[108:111]
  ds_read_b64_tr_b16 v[44:45], v7 offset:9376
  ds_read_b64_tr_b16 v[46:47], v7 offset:13984
  s_waitcnt lgkmcnt(15)
  v_mfma_f32_16x16x32_bf16 v[112:115], v[48:51], v[136:139], v[112:115]
  v_mfma_f32_16x16x32_bf16 v[116:119], v[48:51], v[140:143], v[116:119]
  ds_read_b64_tr_b16 v[48:49], v7 offset:9408
  ds_read_b64_tr_b16 v[50:51], v7 offset:14016
  s_waitcnt lgkmcnt(15)
  v_mfma_f32_16x16x32_bf16 v[120:123], v[52:55], v[136:139], v[120:123]
  v_mfma_f32_16x16x32_bf16 v[124:127], v[52:55], v[140:143], v[124:127]
  ds_read_b64_tr_b16 v[52:53], v7 offset:9440
  ds_read_b64_tr_b16 v[54:55], v7 offset:14048
  s_waitcnt lgkmcnt(15)
  v_mfma_f32_16x16x32_bf16 v[128:131], v[56:59], v[136:139], v[128:131]
  v_mfma_f32_16x16x32_bf16 v[132:135], v[56:59], v[140:143], v[132:135]
  ds_read_b64_tr_b16 v[56:57], v7 offset:9472
  ds_read_b64_tr_b16 v[58:59], v7 offset:14080
  s_barrier
  s_waitcnt lgkmcnt(15)
  v_mfma_f32_16x16x32_bf16 v[64:67], v[24:27], v[144:147], v[64:67]
  ds_read_b128 v[136:139], v4 offset:34816
  ds_read_b128 v[140:143], v4 offset:36864
  v_mfma_f32_16x16x32_bf16 v[68:71], v[24:27], v[148:151], v[68:71]
  ds_read_b64_tr_b16 v[24:25], v7 offset:34816
  ds_read_b64_tr_b16 v[26:27], v7 offset:39424
  s_waitcnt lgkmcnt(15)
  v_mfma_f32_16x16x32_bf16 v[72:75], v[28:31], v[144:147], v[72:75]
  v_mfma_f32_16x16x32_bf16 v[76:79], v[28:31], v[148:151], v[76:79]
  ds_read_b64_tr_b16 v[28:29], v7 offset:34848
  ds_read_b64_tr_b16 v[30:31], v7 offset:39456
  s_waitcnt lgkmcnt(15)
  v_mfma_f32_16x16x32_bf16 v[80:83], v[32:35], v[144:147], v[80:83]
  v_mfma_f32_16x16x32_bf16 v[84:87], v[32:35], v[148:151], v[84:87]
  ds_read_b64_tr_b16 v[32:33], v7 offset:34880
  ds_read_b64_tr_b16 v[34:35], v7 offset:39488
  s_waitcnt lgkmcnt(15)
  v_mfma_f32_16x16x32_bf16 v[88:91], v[36:39], v[144:147], v[88:91]
  v_mfma_f32_16x16x32_bf16 v[92:95], v[36:39], v[148:151], v[92:95]
  ds_read_b64_tr_b16 v[36:37], v7 offset:34912
  ds_read_b64_tr_b16 v[38:39], v7 offset:39520
  s_waitcnt lgkmcnt(15)
  v_mfma_f32_16x16x32_bf16 v[96:99], v[40:43], v[144:147], v[96:99]
  v_mfma_f32_16x16x32_bf16 v[100:103], v[40:43], v[148:151], v[100:103]
  ds_read_b64_tr_b16 v[40:41], v7 offset:34944
  ds_read_b64_tr_b16 v[42:43], v7 offset:39552
  s_waitcnt lgkmcnt(15)
  v_mfma_f32_16x16x32_bf16 v[104:107], v[44:47], v[144:147], v[104:107]
  v_mfma_f32_16x16x32_bf16 v[108:111], v[44:47], v[148:151], v[108:111]
  ds_read_b64_tr_b16 v[44:45], v7 offset:34976
  ds_read_b64_tr_b16 v[46:47], v7 offset:39584
  s_waitcnt lgkmcnt(15)
  v_mfma_f32_16x16x32_bf16 v[112:115], v[48:51], v[144:147], v[112:115]
  v_mfma_f32_16x16x32_bf16 v[116:119], v[48:51], v[148:151], v[116:119]
  ds_read_b64_tr_b16 v[48:49], v7 offset:35008
  ds_read_b64_tr_b16 v[50:51], v7 offset:39616
  s_waitcnt lgkmcnt(15)
  v_mfma_f32_16x16x32_bf16 v[120:123], v[52:55], v[144:147], v[120:123]
  v_mfma_f32_16x16x32_bf16 v[124:127], v[52:55], v[148:151], v[124:127]
  ds_read_b64_tr_b16 v[52:53], v7 offset:35040
  ds_read_b64_tr_b16 v[54:55], v7 offset:39648
  s_waitcnt lgkmcnt(15)
  v_mfma_f32_16x16x32_bf16 v[128:131], v[56:59], v[144:147], v[128:131]
  v_mfma_f32_16x16x32_bf16 v[132:135], v[56:59], v[148:151], v[132:135]
  ds_read_b64_tr_b16 v[56:57], v7 offset:35072
  ds_read_b64_tr_b16 v[58:59], v7 offset:39680
  s_waitcnt lgkmcnt(15)
  v_mfma_f32_16x16x32_bf16 v[64:67], v[24:27], v[136:139], v[64:67]
  ds_read_b128 v[144:147], v5 offset:34816
  ds_read_b128 v[148:151], v5 offset:36864
  v_mfma_f32_16x16x32_bf16 v[68:71], v[24:27], v[140:143], v[68:71]
  ds_read_b64_tr_b16 v[24:25], v7 offset:44032
  ds_read_b64_tr_b16 v[26:27], v7 offset:48640
  s_waitcnt lgkmcnt(15)
  v_mfma_f32_16x16x32_bf16 v[72:75], v[28:31], v[136:139], v[72:75]
  v_mfma_f32_16x16x32_bf16 v[76:79], v[28:31], v[140:143], v[76:79]
  ds_read_b64_tr_b16 v[28:29], v7 offset:44064
  ds_read_b64_tr_b16 v[30:31], v7 offset:48672
  s_waitcnt lgkmcnt(15)
  v_mfma_f32_16x16x32_bf16 v[80:83], v[32:35], v[136:139], v[80:83]
  v_mfma_f32_16x16x32_bf16 v[84:87], v[32:35], v[140:143], v[84:87]
  ds_read_b64_tr_b16 v[32:33], v7 offset:44096
  ds_read_b64_tr_b16 v[34:35], v7 offset:48704
  s_waitcnt lgkmcnt(15)
  v_mfma_f32_16x16x32_bf16 v[88:91], v[36:39], v[136:139], v[88:91]
  v_mfma_f32_16x16x32_bf16 v[92:95], v[36:39], v[140:143], v[92:95]
  ds_read_b64_tr_b16 v[36:37], v7 offset:44128
  ds_read_b64_tr_b16 v[38:39], v7 offset:48736
  s_waitcnt lgkmcnt(15)
  v_mfma_f32_16x16x32_bf16 v[96:99], v[40:43], v[136:139], v[96:99]
  v_mfma_f32_16x16x32_bf16 v[100:103], v[40:43], v[140:143], v[100:103]
  ds_read_b64_tr_b16 v[40:41], v7 offset:44160
  ds_read_b64_tr_b16 v[42:43], v7 offset:48768
  s_waitcnt lgkmcnt(15)
  v_mfma_f32_16x16x32_bf16 v[104:107], v[44:47], v[136:139], v[104:107]
  v_mfma_f32_16x16x32_bf16 v[108:111], v[44:47], v[140:143], v[108:111]
  ds_read_b64_tr_b16 v[44:45], v7 offset:44192
  ds_read_b64_tr_b16 v[46:47], v7 offset:48800
  s_waitcnt lgkmcnt(15)
  v_mfma_f32_16x16x32_bf16 v[112:115], v[48:51], v[136:139], v[112:115]
  v_mfma_f32_16x16x32_bf16 v[116:119], v[48:51], v[140:143], v[116:119]
  ds_read_b64_tr_b16 v[48:49], v7 offset:44224
  ds_read_b64_tr_b16 v[50:51], v7 offset:48832
  s_waitcnt lgkmcnt(15)
  v_mfma_f32_16x16x32_bf16 v[120:123], v[52:55], v[136:139], v[120:123]
  v_mfma_f32_16x16x32_bf16 v[124:127], v[52:55], v[140:143], v[124:127]
  ds_read_b64_tr_b16 v[52:53], v7 offset:44256
  ds_read_b64_tr_b16 v[54:55], v7 offset:48864
  s_waitcnt lgkmcnt(15)
  v_mfma_f32_16x16x32_bf16 v[128:131], v[56:59], v[136:139], v[128:131]
  v_mfma_f32_16x16x32_bf16 v[132:135], v[56:59], v[140:143], v[132:135]
  ds_read_b64_tr_b16 v[56:57], v7 offset:44288
  ds_read_b64_tr_b16 v[58:59], v7 offset:48896
  s_barrier
  s_waitcnt lgkmcnt(15)
  v_mfma_f32_16x16x32_bf16 v[64:67], v[24:27], v[144:147], v[64:67]
  ds_read_b128 v[136:139], v2 offset:0
  ds_read_b128 v[140:143], v2 offset:2048
  v_mfma_f32_16x16x32_bf16 v[68:71], v[24:27], v[148:151], v[68:71]
  ds_read_b64_tr_b16 v[24:25], v6 offset:0
  ds_read_b64_tr_b16 v[26:27], v6 offset:4608
  s_waitcnt lgkmcnt(15)
  v_mfma_f32_16x16x32_bf16 v[72:75], v[28:31], v[144:147], v[72:75]
  v_mfma_f32_16x16x32_bf16 v[76:79], v[28:31], v[148:151], v[76:79]
  ds_read_b64_tr_b16 v[28:29], v6 offset:32
  ds_read_b64_tr_b16 v[30:31], v6 offset:4640
  s_waitcnt lgkmcnt(15)
  v_mfma_f32_16x16x32_bf16 v[80:83], v[32:35], v[144:147], v[80:83]
  v_mfma_f32_16x16x32_bf16 v[84:87], v[32:35], v[148:151], v[84:87]
  ds_read_b64_tr_b16 v[32:33], v6 offset:64
  ds_read_b64_tr_b16 v[34:35], v6 offset:4672
  s_waitcnt lgkmcnt(15)
  v_mfma_f32_16x16x32_bf16 v[88:91], v[36:39], v[144:147], v[88:91]
  v_mfma_f32_16x16x32_bf16 v[92:95], v[36:39], v[148:151], v[92:95]
  ds_read_b64_tr_b16 v[36:37], v6 offset:96
  ds_read_b64_tr_b16 v[38:39], v6 offset:4704
  s_waitcnt lgkmcnt(15)
  v_mfma_f32_16x16x32_bf16 v[96:99], v[40:43], v[144:147], v[96:99]
  v_mfma_f32_16x16x32_bf16 v[100:103], v[40:43], v[148:151], v[100:103]
  ds_read_b64_tr_b16 v[40:41], v6 offset:128
  ds_read_b64_tr_b16 v[42:43], v6 offset:4736
  s_waitcnt lgkmcnt(15)
  v_mfma_f32_16x16x32_bf16 v[104:107], v[44:47], v[144:147], v[104:107]
  v_mfma_f32_16x16x32_bf16 v[108:111], v[44:47], v[148:151], v[108:111]
  ds_read_b64_tr_b16 v[44:45], v6 offset:160
  ds_read_b64_tr_b16 v[46:47], v6 offset:4768
  s_waitcnt lgkmcnt(15)
  v_mfma_f32_16x16x32_bf16 v[112:115], v[48:51], v[144:147], v[112:115]
  v_mfma_f32_16x16x32_bf16 v[116:119], v[48:51], v[148:151], v[116:119]
  ds_read_b64_tr_b16 v[48:49], v6 offset:192
  ds_read_b64_tr_b16 v[50:51], v6 offset:4800
  s_waitcnt lgkmcnt(15)
  v_mfma_f32_16x16x32_bf16 v[120:123], v[52:55], v[144:147], v[120:123]
  v_mfma_f32_16x16x32_bf16 v[124:127], v[52:55], v[148:151], v[124:127]
  ds_read_b64_tr_b16 v[52:53], v6 offset:224
  ds_read_b64_tr_b16 v[54:55], v6 offset:4832
  s_waitcnt lgkmcnt(15)
  v_mfma_f32_16x16x32_bf16 v[128:131], v[56:59], v[144:147], v[128:131]
  v_mfma_f32_16x16x32_bf16 v[132:135], v[56:59], v[148:151], v[132:135]
  ds_read_b64_tr_b16 v[56:57], v6 offset:256
  ds_read_b64_tr_b16 v[58:59], v6 offset:4864
  s_waitcnt lgkmcnt(15)
  v_mfma_f32_16x16x32_bf16 v[64:67], v[24:27], v[136:139], v[64:67]
  ds_read_b128 v[144:147], v3 offset:0
  ds_read_b128 v[148:151], v3 offset:2048
  v_mfma_f32_16x16x32_bf16 v[68:71], v[24:27], v[140:143], v[68:71]
  ds_read_b64_tr_b16 v[24:25], v6 offset:9216
  ds_read_b64_tr_b16 v[26:27], v6 offset:13824
  s_waitcnt lgkmcnt(15)
  v_mfma_f32_16x16x32_bf16 v[72:75], v[28:31], v[136:139], v[72:75]
  v_mfma_f32_16x16x32_bf16 v[76:79], v[28:31], v[140:143], v[76:79]
  ds_read_b64_tr_b16 v[28:29], v6 offset:9248
  ds_read_b64_tr_b16 v[30:31], v6 offset:13856
  s_waitcnt lgkmcnt(15)
  v_mfma_f32_16x16x32_bf16 v[80:83], v[32:35], v[136:139], v[80:83]
  v_mfma_f32_16x16x32_bf16 v[84:87], v[32:35], v[140:143], v[84:87]
  ds_read_b64_tr_b16 v[32:33], v6 offset:9280
  ds_read_b64_tr_b16 v[34:35], v6 offset:13888
  s_waitcnt lgkmcnt(15)
  v_mfma_f32_16x16x32_bf16 v[88:91], v[36:39], v[136:139], v[88:91]
  v_mfma_f32_16x16x32_bf16 v[92:95], v[36:39], v[140:143], v[92:95]
  ds_read_b64_tr_b16 v[36:37], v6 offset:9312
  ds_read_b64_tr_b16 v[38:39], v6 offset:13920
  s_waitcnt lgkmcnt(15)
  v_mfma_f32_16x16x32_bf16 v[96:99], v[40:43], v[136:139], v[96:99]
  v_mfma_f32_16x16x32_bf16 v[100:103], v[40:43], v[140:143], v[100:103]
  ds_read_b64_tr_b16 v[40:41], v6 offset:9344
  ds_read_b64_tr_b16 v[42:43], v6 offset:13952
  s_waitcnt lgkmcnt(15)
  v_mfma_f32_16x16x32_bf16 v[104:107], v[44:47], v[136:139], v[104:107]
  v_mfma_f32_16x16x32_bf16 v[108:111], v[44:47], v[140:143], v[108:111]
  ds_read_b64_tr_b16 v[44:45], v6 offset:9376
  ds_read_b64_tr_b16 v[46:47], v6 offset:13984
  s_waitcnt lgkmcnt(15)
  v_mfma_f32_16x16x32_bf16 v[112:115], v[48:51], v[136:139], v[112:115]
  v_mfma_f32_16x16x32_bf16 v[116:119], v[48:51], v[140:143], v[116:119]
  ds_read_b64_tr_b16 v[48:49], v6 offset:9408
  ds_read_b64_tr_b16 v[50:51], v6 offset:14016
  s_waitcnt lgkmcnt(15)
  v_mfma_f32_16x16x32_bf16 v[120:123], v[52:55], v[136:139], v[120:123]
  v_mfma_f32_16x16x32_bf16 v[124:127], v[52:55], v[140:143], v[124:127]
  ds_read_b64_tr_b16 v[52:53], v6 offset:9440
  ds_read_b64_tr_b16 v[54:55], v6 offset:14048
  s_waitcnt lgkmcnt(15)
  v_mfma_f32_16x16x32_bf16 v[128:131], v[56:59], v[136:139], v[128:131]
  v_mfma_f32_16x16x32_bf16 v[132:135], v[56:59], v[140:143], v[132:135]
  ds_read_b64_tr_b16 v[56:57], v6 offset:9472
  ds_read_b64_tr_b16 v[58:59], v6 offset:14080
  s_barrier
  s_waitcnt lgkmcnt(15)
  v_mfma_f32_16x16x32_bf16 v[64:67], v[24:27], v[144:147], v[64:67]
  ds_read_b128 v[136:139], v2 offset:34816
  ds_read_b128 v[140:143], v2 offset:36864
  v_mfma_f32_16x16x32_bf16 v[68:71], v[24:27], v[148:151], v[68:71]
  ds_read_b64_tr_b16 v[24:25], v6 offset:34816
  ds_read_b64_tr_b16 v[26:27], v6 offset:39424
  s_waitcnt lgkmcnt(15)
  v_mfma_f32_16x16x32_bf16 v[72:75], v[28:31], v[144:147], v[72:75]
  v_mfma_f32_16x16x32_bf16 v[76:79], v[28:31], v[148:151], v[76:79]
  ds_read_b64_tr_b16 v[28:29], v6 offset:34848
  ds_read_b64_tr_b16 v[30:31], v6 offset:39456
  s_waitcnt lgkmcnt(15)
  v_mfma_f32_16x16x32_bf16 v[80:83], v[32:35], v[144:147], v[80:83]
  v_mfma_f32_16x16x32_bf16 v[84:87], v[32:35], v[148:151], v[84:87]
  ds_read_b64_tr_b16 v[32:33], v6 offset:34880
  ds_read_b64_tr_b16 v[34:35], v6 offset:39488
  s_waitcnt lgkmcnt(15)
  v_mfma_f32_16x16x32_bf16 v[88:91], v[36:39], v[144:147], v[88:91]
  v_mfma_f32_16x16x32_bf16 v[92:95], v[36:39], v[148:151], v[92:95]
  ds_read_b64_tr_b16 v[36:37], v6 offset:34912
  ds_read_b64_tr_b16 v[38:39], v6 offset:39520
  s_waitcnt lgkmcnt(15)
  v_mfma_f32_16x16x32_bf16 v[96:99], v[40:43], v[144:147], v[96:99]
  v_mfma_f32_16x16x32_bf16 v[100:103], v[40:43], v[148:151], v[100:103]
  ds_read_b64_tr_b16 v[40:41], v6 offset:34944
  ds_read_b64_tr_b16 v[42:43], v6 offset:39552
  s_waitcnt lgkmcnt(15)
  v_mfma_f32_16x16x32_bf16 v[104:107], v[44:47], v[144:147], v[104:107]
  v_mfma_f32_16x16x32_bf16 v[108:111], v[44:47], v[148:151], v[108:111]
  ds_read_b64_tr_b16 v[44:45], v6 offset:34976
  ds_read_b64_tr_b16 v[46:47], v6 offset:39584
  s_waitcnt lgkmcnt(15)
  v_mfma_f32_16x16x32_bf16 v[112:115], v[48:51], v[144:147], v[112:115]
  v_mfma_f32_16x16x32_bf16 v[116:119], v[48:51], v[148:151], v[116:119]
  ds_read_b64_tr_b16 v[48:49], v6 offset:35008
  ds_read_b64_tr_b16 v[50:51], v6 offset:39616
  s_waitcnt lgkmcnt(15)
  v_mfma_f32_16x16x32_bf16 v[120:123], v[52:55], v[144:147], v[120:123]
  v_mfma_f32_16x16x32_bf16 v[124:127], v[52:55], v[148:151], v[124:127]
  ds_read_b64_tr_b16 v[52:53], v6 offset:35040
  ds_read_b64_tr_b16 v[54:55], v6 offset:39648
  s_waitcnt lgkmcnt(15)
  v_mfma_f32_16x16x32_bf16 v[128:131], v[56:59], v[144:147], v[128:131]
  v_mfma_f32_16x16x32_bf16 v[132:135], v[56:59], v[148:151], v[132:135]
  ds_read_b64_tr_b16 v[56:57], v6 offset:35072
  ds_read_b64_tr_b16 v[58:59], v6 offset:39680
  s_waitcnt lgkmcnt(15)
  v_mfma_f32_16x16x32_bf16 v[64:67], v[24:27], v[136:139], v[64:67]
  ds_read_b128 v[144:147], v3 offset:34816
  ds_read_b128 v[148:151], v3 offset:36864
  v_mfma_f32_16x16x32_bf16 v[68:71], v[24:27], v[140:143], v[68:71]
  ds_read_b64_tr_b16 v[24:25], v6 offset:44032
  ds_read_b64_tr_b16 v[26:27], v6 offset:48640
  s_waitcnt lgkmcnt(15)
  v_mfma_f32_16x16x32_bf16 v[72:75], v[28:31], v[136:139], v[72:75]
  v_mfma_f32_16x16x32_bf16 v[76:79], v[28:31], v[140:143], v[76:79]
  ds_read_b64_tr_b16 v[28:29], v6 offset:44064
  ds_read_b64_tr_b16 v[30:31], v6 offset:48672
  s_waitcnt lgkmcnt(15)
  v_mfma_f32_16x16x32_bf16 v[80:83], v[32:35], v[136:139], v[80:83]
  v_mfma_f32_16x16x32_bf16 v[84:87], v[32:35], v[140:143], v[84:87]
  ds_read_b64_tr_b16 v[32:33], v6 offset:44096
  ds_read_b64_tr_b16 v[34:35], v6 offset:48704
  s_waitcnt lgkmcnt(15)
  v_mfma_f32_16x16x32_bf16 v[88:91], v[36:39], v[136:139], v[88:91]
  v_mfma_f32_16x16x32_bf16 v[92:95], v[36:39], v[140:143], v[92:95]
  ds_read_b64_tr_b16 v[36:37], v6 offset:44128
  ds_read_b64_tr_b16 v[38:39], v6 offset:48736
  s_waitcnt lgkmcnt(15)
  v_mfma_f32_16x16x32_bf16 v[96:99], v[40:43], v[136:139], v[96:99]
  v_mfma_f32_16x16x32_bf16 v[100:103], v[40:43], v[140:143], v[100:103]
  ds_read_b64_tr_b16 v[40:41], v6 offset:44160
  ds_read_b64_tr_b16 v[42:43], v6 offset:48768
  s_waitcnt lgkmcnt(15)
  v_mfma_f32_16x16x32_bf16 v[104:107], v[44:47], v[136:139], v[104:107]
  v_mfma_f32_16x16x32_bf16 v[108:111], v[44:47], v[140:143], v[108:111]
  ds_read_b64_tr_b16 v[44:45], v6 offset:44192
  ds_read_b64_tr_b16 v[46:47], v6 offset:48800
  s_waitcnt lgkmcnt(15)
  v_mfma_f32_16x16x32_bf16 v[112:115], v[48:51], v[136:139], v[112:115]
  v_mfma_f32_16x16x32_bf16 v[116:119], v[48:51], v[140:143], v[116:119]
  ds_read_b64_tr_b16 v[48:49], v6 offset:44224
  ds_read_b64_tr_b16 v[50:51], v6 offset:48832
  s_waitcnt lgkmcnt(15)
  v_mfma_f32_16x16x32_bf16 v[120:123], v[52:55], v[136:139], v[120:123]
  v_mfma_f32_16x16x32_bf16 v[124:127], v[52:55], v[140:143], v[124:127]
  ds_read_b64_tr_b16 v[52:53], v6 offset:44256
  ds_read_b64_tr_b16 v[54:55], v6 offset:48864
  s_waitcnt lgkmcnt(15)
  v_mfma_f32_16x16x32_bf16 v[128:131], v[56:59], v[136:139], v[128:131]
  v_mfma_f32_16x16x32_bf16 v[132:135], v[56:59], v[140:143], v[132:135]
  ds_read_b64_tr_b16 v[56:57], v6 offset:44288
  ds_read_b64_tr_b16 v[58:59], v6 offset:48896
  s_barrier
  s_waitcnt lgkmcnt(15)
  v_mfma_f32_16x16x32_bf16 v[64:67], v[24:27], v[144:147], v[64:67]
  ds_read_b128 v[136:139], v4 offset:0
  ds_read_b128 v[140:143], v4 offset:2048
  v_mfma_f32_16x16x32_bf16 v[68:71], v[24:27], v[148:151], v[68:71]
  ds_read_b64_tr_b16 v[24:25], v7 offset:0
  ds_read_b64_tr_b16 v[26:27], v7 offset:4608
  s_waitcnt lgkmcnt(15)
  v_mfma_f32_16x16x32_bf16 v[72:75], v[28:31], v[144:147], v[72:75]
  v_mfma_f32_16x16x32_bf16 v[76:79], v[28:31], v[148:151], v[76:79]
  ds_read_b64_tr_b16 v[28:29], v7 offset:32
  ds_read_b64_tr_b16 v[30:31], v7 offset:4640
  s_waitcnt lgkmcnt(15)
  v_mfma_f32_16x16x32_bf16 v[80:83], v[32:35], v[144:147], v[80:83]
  v_mfma_f32_16x16x32_bf16 v[84:87], v[32:35], v[148:151], v[84:87]
  ds_read_b64_tr_b16 v[32:33], v7 offset:64
  ds_read_b64_tr_b16 v[34:35], v7 offset:4672
  s_waitcnt lgkmcnt(15)
  v_mfma_f32_16x16x32_bf16 v[88:91], v[36:39], v[144:147], v[88:91]
  v_mfma_f32_16x16x32_bf16 v[92:95], v[36:39], v[148:151], v[92:95]
  ds_read_b64_tr_b16 v[36:37], v7 offset:96
  ds_read_b64_tr_b16 v[38:39], v7 offset:4704
  s_waitcnt lgkmcnt(15)
  v_mfma_f32_16x16x32_bf16 v[96:99], v[40:43], v[144:147], v[96:99]
  v_mfma_f32_16x16x32_bf16 v[100:103], v[40:43], v[148:151], v[100:103]
  ds_read_b64_tr_b16 v[40:41], v7 offset:128
  ds_read_b64_tr_b16 v[42:43], v7 offset:4736
  s_waitcnt lgkmcnt(15)
  v_mfma_f32_16x16x32_bf16 v[104:107], v[44:47], v[144:147], v[104:107]
  v_mfma_f32_16x16x32_bf16 v[108:111], v[44:47], v[148:151], v[108:111]
  ds_read_b64_tr_b16 v[44:45], v7 offset:160
  ds_read_b64_tr_b16 v[46:47], v7 offset:4768
  s_waitcnt lgkmcnt(15)
  v_mfma_f32_16x16x32_bf16 v[112:115], v[48:51], v[144:147], v[112:115]
  v_mfma_f32_16x16x32_bf16 v[116:119], v[48:51], v[148:151], v[116:119]
  ds_read_b64_tr_b16 v[48:49], v7 offset:192
  ds_read_b64_tr_b16 v[50:51], v7 offset:4800
  s_waitcnt lgkmcnt(15)
  v_mfma_f32_16x16x32_bf16 v[120:123], v[52:55], v[144:147], v[120:123]
  v_mfma_f32_16x16x32_bf16 v[124:127], v[52:55], v[148:151], v[124:127]
  ds_read_b64_tr_b16 v[52:53], v7 offset:224
  ds_read_b64_tr_b16 v[54:55], v7 offset:4832
  s_waitcnt lgkmcnt(15)
  v_mfma_f32_16x16x32_bf16 v[128:131], v[56:59], v[144:147], v[128:131]
  v_mfma_f32_16x16x32_bf16 v[132:135], v[56:59], v[148:151], v[132:135]
  ds_read_b64_tr_b16 v[56:57], v7 offset:256
  ds_read_b64_tr_b16 v[58:59], v7 offset:4864
  s_waitcnt lgkmcnt(15)
  v_mfma_f32_16x16x32_bf16 v[64:67], v[24:27], v[136:139], v[64:67]
  ds_read_b128 v[144:147], v5 offset:0
  ds_read_b128 v[148:151], v5 offset:2048
  v_mfma_f32_16x16x32_bf16 v[68:71], v[24:27], v[140:143], v[68:71]
  ds_read_b64_tr_b16 v[24:25], v7 offset:9216
  ds_read_b64_tr_b16 v[26:27], v7 offset:13824
  s_waitcnt lgkmcnt(15)
  v_mfma_f32_16x16x32_bf16 v[72:75], v[28:31], v[136:139], v[72:75]
  v_mfma_f32_16x16x32_bf16 v[76:79], v[28:31], v[140:143], v[76:79]
  ds_read_b64_tr_b16 v[28:29], v7 offset:9248
  ds_read_b64_tr_b16 v[30:31], v7 offset:13856
  s_waitcnt lgkmcnt(15)
  v_mfma_f32_16x16x32_bf16 v[80:83], v[32:35], v[136:139], v[80:83]
  v_mfma_f32_16x16x32_bf16 v[84:87], v[32:35], v[140:143], v[84:87]
  ds_read_b64_tr_b16 v[32:33], v7 offset:9280
  ds_read_b64_tr_b16 v[34:35], v7 offset:13888
  s_waitcnt lgkmcnt(15)
  v_mfma_f32_16x16x32_bf16 v[88:91], v[36:39], v[136:139], v[88:91]
  v_mfma_f32_16x16x32_bf16 v[92:95], v[36:39], v[140:143], v[92:95]
  ds_read_b64_tr_b16 v[36:37], v7 offset:9312
  ds_read_b64_tr_b16 v[38:39], v7 offset:13920
  s_waitcnt lgkmcnt(15)
  v_mfma_f32_16x16x32_bf16 v[96:99], v[40:43], v[136:139], v[96:99]
  v_mfma_f32_16x16x32_bf16 v[100:103], v[40:43], v[140:143], v[100:103]
  ds_read_b64_tr_b16 v[40:41], v7 offset:9344
  ds_read_b64_tr_b16 v[42:43], v7 offset:13952
  s_waitcnt lgkmcnt(15)
  v_mfma_f32_16x16x32_bf16 v[104:107], v[44:47], v[136:139], v[104:107]
  v_mfma_f32_16x16x32_bf16 v[108:111], v[44:47], v[140:143], v[108:111]
  ds_read_b64_tr_b16 v[44:45], v7 offset:9376
  ds_read_b64_tr_b16 v[46:47], v7 offset:13984
  s_waitcnt lgkmcnt(15)
  v_mfma_f32_16x16x32_bf16 v[112:115], v[48:51], v[136:139], v[112:115]
  v_mfma_f32_16x16x32_bf16 v[116:119], v[48:51], v[140:143], v[116:119]
  ds_read_b64_tr_b16 v[48:49], v7 offset:9408
  ds_read_b64_tr_b16 v[50:51], v7 offset:14016
  s_waitcnt lgkmcnt(15)
  v_mfma_f32_16x16x32_bf16 v[120:123], v[52:55], v[136:139], v[120:123]
  v_mfma_f32_16x16x32_bf16 v[124:127], v[52:55], v[140:143], v[124:127]
  ds_read_b64_tr_b16 v[52:53], v7 offset:9440
  ds_read_b64_tr_b16 v[54:55], v7 offset:14048
  s_waitcnt lgkmcnt(15)
  v_mfma_f32_16x16x32_bf16 v[128:131], v[56:59], v[136:139], v[128:131]
  v_mfma_f32_16x16x32_bf16 v[132:135], v[56:59], v[140:143], v[132:135]
  ds_read_b64_tr_b16 v[56:57], v7 offset:9472
  ds_read_b64_tr_b16 v[58:59], v7 offset:14080
  s_barrier
  s_waitcnt lgkmcnt(15)
  v_mfma_f32_16x16x32_bf16 v[64:67], v[24:27], v[144:147], v[64:67]
  ds_read_b128 v[136:139], v4 offset:34816
  ds_read_b128 v[140:143], v4 offset:36864
  v_mfma_f32_16x16x32_bf16 v[68:71], v[24:27], v[148:151], v[68:71]
  ds_read_b64_tr_b16 v[24:25], v7 offset:34816
  ds_read_b64_tr_b16 v[26:27], v7 offset:39424
  s_waitcnt lgkmcnt(15)
  v_mfma_f32_16x16x32_bf16 v[72:75], v[28:31], v[144:147], v[72:75]
  v_mfma_f32_16x16x32_bf16 v[76:79], v[28:31], v[148:151], v[76:79]
  ds_read_b64_tr_b16 v[28:29], v7 offset:34848
  ds_read_b64_tr_b16 v[30:31], v7 offset:39456
  s_waitcnt lgkmcnt(15)
  v_mfma_f32_16x16x32_bf16 v[80:83], v[32:35], v[144:147], v[80:83]
  v_mfma_f32_16x16x32_bf16 v[84:87], v[32:35], v[148:151], v[84:87]
  ds_read_b64_tr_b16 v[32:33], v7 offset:34880
  ds_read_b64_tr_b16 v[34:35], v7 offset:39488
  s_waitcnt lgkmcnt(15)
  v_mfma_f32_16x16x32_bf16 v[88:91], v[36:39], v[144:147], v[88:91]
  v_mfma_f32_16x16x32_bf16 v[92:95], v[36:39], v[148:151], v[92:95]
  ds_read_b64_tr_b16 v[36:37], v7 offset:34912
  ds_read_b64_tr_b16 v[38:39], v7 offset:39520
  s_waitcnt lgkmcnt(15)
  v_mfma_f32_16x16x32_bf16 v[96:99], v[40:43], v[144:147], v[96:99]
  v_mfma_f32_16x16x32_bf16 v[100:103], v[40:43], v[148:151], v[100:103]
  ds_read_b64_tr_b16 v[40:41], v7 offset:34944
  ds_read_b64_tr_b16 v[42:43], v7 offset:39552
  s_waitcnt lgkmcnt(15)
  v_mfma_f32_16x16x32_bf16 v[104:107], v[44:47], v[144:147], v[104:107]
  v_mfma_f32_16x16x32_bf16 v[108:111], v[44:47], v[148:151], v[108:111]
  ds_read_b64_tr_b16 v[44:45], v7 offset:34976
  ds_read_b64_tr_b16 v[46:47], v7 offset:39584
  s_waitcnt lgkmcnt(15)
  v_mfma_f32_16x16x32_bf16 v[112:115], v[48:51], v[144:147], v[112:115]
  v_mfma_f32_16x16x32_bf16 v[116:119], v[48:51], v[148:151], v[116:119]
  ds_read_b64_tr_b16 v[48:49], v7 offset:35008
  ds_read_b64_tr_b16 v[50:51], v7 offset:39616
  s_waitcnt lgkmcnt(15)
  v_mfma_f32_16x16x32_bf16 v[120:123], v[52:55], v[144:147], v[120:123]
  v_mfma_f32_16x16x32_bf16 v[124:127], v[52:55], v[148:151], v[124:127]
  ds_read_b64_tr_b16 v[52:53], v7 offset:35040
  ds_read_b64_tr_b16 v[54:55], v7 offset:39648
  s_waitcnt lgkmcnt(15)
  v_mfma_f32_16x16x32_bf16 v[128:131], v[56:59], v[144:147], v[128:131]
  v_mfma_f32_16x16x32_bf16 v[132:135], v[56:59], v[148:151], v[132:135]
  ds_read_b64_tr_b16 v[56:57], v7 offset:35072
  ds_read_b64_tr_b16 v[58:59], v7 offset:39680
  s_waitcnt lgkmcnt(15)
  v_mfma_f32_16x16x32_bf16 v[64:67], v[24:27], v[136:139], v[64:67]
  ds_read_b128 v[144:147], v5 offset:34816
  ds_read_b128 v[148:151], v5 offset:36864
  v_mfma_f32_16x16x32_bf16 v[68:71], v[24:27], v[140:143], v[68:71]
  ds_read_b64_tr_b16 v[24:25], v7 offset:44032
  ds_read_b64_tr_b16 v[26:27], v7 offset:48640
  s_waitcnt lgkmcnt(15)
  v_mfma_f32_16x16x32_bf16 v[72:75], v[28:31], v[136:139], v[72:75]
  v_mfma_f32_16x16x32_bf16 v[76:79], v[28:31], v[140:143], v[76:79]
  ds_read_b64_tr_b16 v[28:29], v7 offset:44064
  ds_read_b64_tr_b16 v[30:31], v7 offset:48672
  s_waitcnt lgkmcnt(15)
  v_mfma_f32_16x16x32_bf16 v[80:83], v[32:35], v[136:139], v[80:83]
  v_mfma_f32_16x16x32_bf16 v[84:87], v[32:35], v[140:143], v[84:87]
  ds_read_b64_tr_b16 v[32:33], v7 offset:44096
  ds_read_b64_tr_b16 v[34:35], v7 offset:48704
  s_waitcnt lgkmcnt(15)
  v_mfma_f32_16x16x32_bf16 v[88:91], v[36:39], v[136:139], v[88:91]
  v_mfma_f32_16x16x32_bf16 v[92:95], v[36:39], v[140:143], v[92:95]
  ds_read_b64_tr_b16 v[36:37], v7 offset:44128
  ds_read_b64_tr_b16 v[38:39], v7 offset:48736
  s_waitcnt lgkmcnt(15)
  v_mfma_f32_16x16x32_bf16 v[96:99], v[40:43], v[136:139], v[96:99]
  v_mfma_f32_16x16x32_bf16 v[100:103], v[40:43], v[140:143], v[100:103]
  ds_read_b64_tr_b16 v[40:41], v7 offset:44160
  ds_read_b64_tr_b16 v[42:43], v7 offset:48768
  s_waitcnt lgkmcnt(15)
  v_mfma_f32_16x16x32_bf16 v[104:107], v[44:47], v[136:139], v[104:107]
  v_mfma_f32_16x16x32_bf16 v[108:111], v[44:47], v[140:143], v[108:111]
  ds_read_b64_tr_b16 v[44:45], v7 offset:44192
  ds_read_b64_tr_b16 v[46:47], v7 offset:48800
  s_waitcnt lgkmcnt(15)
  v_mfma_f32_16x16x32_bf16 v[112:115], v[48:51], v[136:139], v[112:115]
  v_mfma_f32_16x16x32_bf16 v[116:119], v[48:51], v[140:143], v[116:119]
  ds_read_b64_tr_b16 v[48:49], v7 offset:44224
  ds_read_b64_tr_b16 v[50:51], v7 offset:48832
  s_waitcnt lgkmcnt(15)
  v_mfma_f32_16x16x32_bf16 v[120:123], v[52:55], v[136:139], v[120:123]
  v_mfma_f32_16x16x32_bf16 v[124:127], v[52:55], v[140:143], v[124:127]
  ds_read_b64_tr_b16 v[52:53], v7 offset:44256
  ds_read_b64_tr_b16 v[54:55], v7 offset:48864
  s_waitcnt lgkmcnt(15)
  v_mfma_f32_16x16x32_bf16 v[128:131], v[56:59], v[136:139], v[128:131]
  v_mfma_f32_16x16x32_bf16 v[132:135], v[56:59], v[140:143], v[132:135]
  ds_read_b64_tr_b16 v[56:57], v7 offset:44288
  ds_read_b64_tr_b16 v[58:59], v7 offset:48896
  s_barrier
  s_waitcnt lgkmcnt(15)
  v_mfma_f32_16x16x32_bf16 v[64:67], v[24:27], v[144:147], v[64:67]
  ds_read_b128 v[136:139], v2 offset:0
  ds_read_b128 v[140:143], v2 offset:2048
  v_mfma_f32_16x16x32_bf16 v[68:71], v[24:27], v[148:151], v[68:71]
  ds_read_b64_tr_b16 v[24:25], v6 offset:0
  ds_read_b64_tr_b16 v[26:27], v6 offset:4608
  s_waitcnt lgkmcnt(15)
  v_mfma_f32_16x16x32_bf16 v[72:75], v[28:31], v[144:147], v[72:75]
  v_mfma_f32_16x16x32_bf16 v[76:79], v[28:31], v[148:151], v[76:79]
  ds_read_b64_tr_b16 v[28:29], v6 offset:32
  ds_read_b64_tr_b16 v[30:31], v6 offset:4640
  s_waitcnt lgkmcnt(15)
  v_mfma_f32_16x16x32_bf16 v[80:83], v[32:35], v[144:147], v[80:83]
  v_mfma_f32_16x16x32_bf16 v[84:87], v[32:35], v[148:151], v[84:87]
  ds_read_b64_tr_b16 v[32:33], v6 offset:64
  ds_read_b64_tr_b16 v[34:35], v6 offset:4672
  s_waitcnt lgkmcnt(15)
  v_mfma_f32_16x16x32_bf16 v[88:91], v[36:39], v[144:147], v[88:91]
  v_mfma_f32_16x16x32_bf16 v[92:95], v[36:39], v[148:151], v[92:95]
  ds_read_b64_tr_b16 v[36:37], v6 offset:96
  ds_read_b64_tr_b16 v[38:39], v6 offset:4704
  s_waitcnt lgkmcnt(15)
  v_mfma_f32_16x16x32_bf16 v[96:99], v[40:43], v[144:147], v[96:99]
  v_mfma_f32_16x16x32_bf16 v[100:103], v[40:43], v[148:151], v[100:103]
  ds_read_b64_tr_b16 v[40:41], v6 offset:128
  ds_read_b64_tr_b16 v[42:43], v6 offset:4736
  s_waitcnt lgkmcnt(15)
  v_mfma_f32_16x16x32_bf16 v[104:107], v[44:47], v[144:147], v[104:107]
  v_mfma_f32_16x16x32_bf16 v[108:111], v[44:47], v[148:151], v[108:111]
  ds_read_b64_tr_b16 v[44:45], v6 offset:160
  ds_read_b64_tr_b16 v[46:47], v6 offset:4768
  s_waitcnt lgkmcnt(15)
  v_mfma_f32_16x16x32_bf16 v[112:115], v[48:51], v[144:147], v[112:115]
  v_mfma_f32_16x16x32_bf16 v[116:119], v[48:51], v[148:151], v[116:119]
  ds_read_b64_tr_b16 v[48:49], v6 offset:192
  ds_read_b64_tr_b16 v[50:51], v6 offset:4800
  s_waitcnt lgkmcnt(15)
  v_mfma_f32_16x16x32_bf16 v[120:123], v[52:55], v[144:147], v[120:123]
  v_mfma_f32_16x16x32_bf16 v[124:127], v[52:55], v[148:151], v[124:127]
  ds_read_b64_tr_b16 v[52:53], v6 offset:224
  ds_read_b64_tr_b16 v[54:55], v6 offset:4832
  s_waitcnt lgkmcnt(15)
  v_mfma_f32_16x16x32_bf16 v[128:131], v[56:59], v[144:147], v[128:131]
  v_mfma_f32_16x16x32_bf16 v[132:135], v[56:59], v[148:151], v[132:135]
  ds_read_b64_tr_b16 v[56:57], v6 offset:256
  ds_read_b64_tr_b16 v[58:59], v6 offset:4864
  ds_read_b128 v[144:147], v3 offset:0
  ds_read_b128 v[148:151], v3 offset:2048
  ds_read_b64_tr_b16 v[60:61], v6 offset:9216
  ds_read_b64_tr_b16 v[62:63], v6 offset:13824
  ds_read_b64_tr_b16 v[160:161], v6 offset:9248
  ds_read_b64_tr_b16 v[162:163], v6 offset:13856
  s_waitcnt lgkmcnt(2)
  v_mfma_f32_16x16x32_bf16 v[64:67], v[24:27], v[136:139], v[64:67]
  ds_read_b64_tr_b16 v[164:165], v6 offset:9280
  ds_read_b64_tr_b16 v[166:167], v6 offset:13888
  v_mfma_f32_16x16x32_bf16 v[68:71], v[24:27], v[140:143], v[68:71]
  v_mfma_f32_16x16x32_bf16 v[64:67], v[60:63], v[144:147], v[64:67]
  v_mfma_f32_16x16x32_bf16 v[68:71], v[60:63], v[148:151], v[68:71]
  s_waitcnt lgkmcnt(2)
  v_mfma_f32_16x16x32_bf16 v[72:75], v[28:31], v[136:139], v[72:75]
  ds_read_b64_tr_b16 v[60:61], v6 offset:9312
  ds_read_b64_tr_b16 v[62:63], v6 offset:13920
  s_nop 2
  v_pk_mul_f32 v[64:65], v[64:65], s[36:37]
  v_pk_mul_f32 v[66:67], v[66:67], s[36:37]
  v_cvt_pk_bf16_f32 v152, v64, v65
  v_mfma_f32_16x16x32_bf16 v[76:79], v[28:31], v[140:143], v[76:79]
  v_cvt_pk_bf16_f32 v153, v66, v67
  ds_write_b64 v12, v[152:153] offset:0
  v_mfma_f32_16x16x32_bf16 v[72:75], v[160:163], v[144:147], v[72:75]
  v_pk_mul_f32 v[68:69], v[68:69], s[36:37]
  v_pk_mul_f32 v[70:71], v[70:71], s[36:37]
  v_cvt_pk_bf16_f32 v154, v68, v69
  v_mfma_f32_16x16x32_bf16 v[76:79], v[160:163], v[148:151], v[76:79]
  v_cvt_pk_bf16_f32 v155, v70, v71
  ds_write_b64 v12, v[154:155] offset:1152
  s_waitcnt lgkmcnt(4)
  v_mfma_f32_16x16x32_bf16 v[80:83], v[32:35], v[136:139], v[80:83]
  ds_read_b64_tr_b16 v[160:161], v6 offset:9344
  ds_read_b64_tr_b16 v[162:163], v6 offset:13952
  v_pk_mul_f32 v[72:73], v[72:73], s[36:37]
  v_pk_mul_f32 v[74:75], v[74:75], s[36:37]
  v_cvt_pk_bf16_f32 v156, v72, v73
  v_mfma_f32_16x16x32_bf16 v[84:87], v[32:35], v[140:143], v[84:87]
  v_cvt_pk_bf16_f32 v157, v74, v75
  ds_write_b64 v13, v[156:157] offset:32
  v_mfma_f32_16x16x32_bf16 v[80:83], v[164:167], v[144:147], v[80:83]
  v_pk_mul_f32 v[76:77], v[76:77], s[36:37]
  v_pk_mul_f32 v[78:79], v[78:79], s[36:37]
  v_cvt_pk_bf16_f32 v158, v76, v77
  v_mfma_f32_16x16x32_bf16 v[84:87], v[164:167], v[148:151], v[84:87]
  v_cvt_pk_bf16_f32 v159, v78, v79
  ds_write_b64 v13, v[158:159] offset:1184
  s_waitcnt lgkmcnt(6)
  v_mfma_f32_16x16x32_bf16 v[88:91], v[36:39], v[136:139], v[88:91]
  ds_read_b64_tr_b16 v[164:165], v6 offset:9376
  ds_read_b64_tr_b16 v[166:167], v6 offset:13984
  v_pk_mul_f32 v[80:81], v[80:81], s[36:37]
  v_pk_mul_f32 v[82:83], v[82:83], s[36:37]
  v_cvt_pk_bf16_f32 v152, v80, v81
  v_mfma_f32_16x16x32_bf16 v[92:95], v[36:39], v[140:143], v[92:95]
  v_cvt_pk_bf16_f32 v153, v82, v83
  ds_write_b64 v14, v[152:153] offset:64
  v_mfma_f32_16x16x32_bf16 v[88:91], v[60:63], v[144:147], v[88:91]
  v_pk_mul_f32 v[84:85], v[84:85], s[36:37]
  v_pk_mul_f32 v[86:87], v[86:87], s[36:37]
  v_cvt_pk_bf16_f32 v154, v84, v85
  v_mfma_f32_16x16x32_bf16 v[92:95], v[60:63], v[148:151], v[92:95]
  v_cvt_pk_bf16_f32 v155, v86, v87
  ds_write_b64 v14, v[154:155] offset:1216
  s_waitcnt lgkmcnt(6)
  v_mfma_f32_16x16x32_bf16 v[96:99], v[40:43], v[136:139], v[96:99]
  ds_read_b64_tr_b16 v[60:61], v6 offset:9408
  ds_read_b64_tr_b16 v[62:63], v6 offset:14016
  v_pk_mul_f32 v[88:89], v[88:89], s[36:37]
  v_pk_mul_f32 v[90:91], v[90:91], s[36:37]
  v_cvt_pk_bf16_f32 v156, v88, v89
  v_mfma_f32_16x16x32_bf16 v[100:103], v[40:43], v[140:143], v[100:103]
  v_cvt_pk_bf16_f32 v157, v90, v91
  ds_write_b64 v15, v[156:157] offset:96
  v_mfma_f32_16x16x32_bf16 v[96:99], v[160:163], v[144:147], v[96:99]
  v_pk_mul_f32 v[92:93], v[92:93], s[36:37]
  v_pk_mul_f32 v[94:95], v[94:95], s[36:37]
  v_cvt_pk_bf16_f32 v158, v92, v93
  v_mfma_f32_16x16x32_bf16 v[100:103], v[160:163], v[148:151], v[100:103]
  v_cvt_pk_bf16_f32 v159, v94, v95
  ds_write_b64 v15, v[158:159] offset:1248
  s_waitcnt lgkmcnt(6)
  v_mfma_f32_16x16x32_bf16 v[104:107], v[44:47], v[136:139], v[104:107]
  ds_read_b64_tr_b16 v[160:161], v6 offset:9440
  ds_read_b64_tr_b16 v[162:163], v6 offset:14048
  v_pk_mul_f32 v[96:97], v[96:97], s[36:37]
  v_pk_mul_f32 v[98:99], v[98:99], s[36:37]
  v_cvt_pk_bf16_f32 v152, v96, v97
  v_mfma_f32_16x16x32_bf16 v[108:111], v[44:47], v[140:143], v[108:111]
  v_cvt_pk_bf16_f32 v153, v98, v99
  ds_write_b64 v16, v[152:153] offset:128
  v_mfma_f32_16x16x32_bf16 v[104:107], v[164:167], v[144:147], v[104:107]
  v_pk_mul_f32 v[100:101], v[100:101], s[36:37]
  v_pk_mul_f32 v[102:103], v[102:103], s[36:37]
  v_cvt_pk_bf16_f32 v154, v100, v101
  v_mfma_f32_16x16x32_bf16 v[108:111], v[164:167], v[148:151], v[108:111]
  v_cvt_pk_bf16_f32 v155, v102, v103
  ds_write_b64 v16, v[154:155] offset:1280
  s_waitcnt lgkmcnt(6)
  v_mfma_f32_16x16x32_bf16 v[112:115], v[48:51], v[136:139], v[112:115]
  ds_read_b64_tr_b16 v[164:165], v6 offset:9472
  ds_read_b64_tr_b16 v[166:167], v6 offset:14080
  v_pk_mul_f32 v[104:105], v[104:105], s[36:37]
  v_pk_mul_f32 v[106:107], v[106:107], s[36:37]
  v_cvt_pk_bf16_f32 v156, v104, v105
  v_mfma_f32_16x16x32_bf16 v[116:119], v[48:51], v[140:143], v[116:119]
  v_cvt_pk_bf16_f32 v157, v106, v107
  ds_write_b64 v17, v[156:157] offset:160
  v_mfma_f32_16x16x32_bf16 v[112:115], v[60:63], v[144:147], v[112:115]
  v_pk_mul_f32 v[108:109], v[108:109], s[36:37]
  v_pk_mul_f32 v[110:111], v[110:111], s[36:37]
  v_cvt_pk_bf16_f32 v158, v108, v109
  v_mfma_f32_16x16x32_bf16 v[116:119], v[60:63], v[148:151], v[116:119]
  v_cvt_pk_bf16_f32 v159, v110, v111
  ds_write_b64 v17, v[158:159] offset:1312
  s_waitcnt lgkmcnt(6)
  v_mfma_f32_16x16x32_bf16 v[120:123], v[52:55], v[136:139], v[120:123]
  v_pk_mul_f32 v[112:113], v[112:113], s[36:37]
  v_pk_mul_f32 v[114:115], v[114:115], s[36:37]
  v_cvt_pk_bf16_f32 v152, v112, v113
  v_mfma_f32_16x16x32_bf16 v[124:127], v[52:55], v[140:143], v[124:127]
  v_cvt_pk_bf16_f32 v153, v114, v115
  ds_write_b64 v18, v[152:153] offset:192
  v_mfma_f32_16x16x32_bf16 v[120:123], v[160:163], v[144:147], v[120:123]
  v_pk_mul_f32 v[116:117], v[116:117], s[36:37]
  v_pk_mul_f32 v[118:119], v[118:119], s[36:37]
  v_cvt_pk_bf16_f32 v154, v116, v117
  v_mfma_f32_16x16x32_bf16 v[124:127], v[160:163], v[148:151], v[124:127]
  v_cvt_pk_bf16_f32 v155, v118, v119
  ds_write_b64 v18, v[154:155] offset:1344
  s_waitcnt lgkmcnt(4)
  v_mfma_f32_16x16x32_bf16 v[128:131], v[56:59], v[136:139], v[128:131]
  v_pk_mul_f32 v[120:121], v[120:121], s[36:37]
  v_pk_mul_f32 v[122:123], v[122:123], s[36:37]
  v_cvt_pk_bf16_f32 v156, v120, v121
  v_mfma_f32_16x16x32_bf16 v[132:135], v[56:59], v[140:143], v[132:135]
  v_cvt_pk_bf16_f32 v157, v122, v123
  ds_write_b64 v19, v[156:157] offset:224
  v_mfma_f32_16x16x32_bf16 v[128:131], v[164:167], v[144:147], v[128:131]
  v_pk_mul_f32 v[124:125], v[124:125], s[36:37]
  v_pk_mul_f32 v[126:127], v[126:127], s[36:37]
  v_cvt_pk_bf16_f32 v158, v124, v125
  v_mfma_f32_16x16x32_bf16 v[132:135], v[164:167], v[148:151], v[132:135]
  v_cvt_pk_bf16_f32 v159, v126, v127
  ds_write_b64 v19, v[158:159] offset:1376
  s_nop 1
  v_pk_mul_f32 v[128:129], v[128:129], s[36:37]
  v_pk_mul_f32 v[130:131], v[130:131], s[36:37]
  v_cvt_pk_bf16_f32 v152, v128, v129
  v_cvt_pk_bf16_f32 v153, v130, v131
  ds_write_b64 v20, v[152:153] offset:256
  v_pk_mul_f32 v[132:133], v[132:133], s[36:37]
  v_pk_mul_f32 v[134:135], v[134:135], s[36:37]
  v_cvt_pk_bf16_f32 v154, v132, v133
  v_cvt_pk_bf16_f32 v155, v134, v135
  ds_write_b64 v20, v[154:155] offset:1408
  s_waitcnt lgkmcnt(0)
L_copy:
  v_lshlrev_b32 v1, 4, v0
  s_lshl_b32 s36, s3, 10
  v_add_u32 v2, s36, v1
  v_add_u32 v3, 67584, v2
  s_add_u32 s24, s8, 0
  s_addc_u32 s25, s9, 0
  s_and_b32 s25, s25, 0xffff
  s_mov_b32 s26, 7077888
  s_mov_b32 s27, 0x20000
  s_mul_i32 s65, s65, 0x9e3779b1
  s_add_u32 s65, s65, 0x7f4a7c15
  s_barrier
  ds_read_b128 v[4:7], v2 offset:34816
  ds_read_b128 v[8:11], v2 offset:43008
  ds_read_b128 v[12:15], v2 offset:51200
  ds_read_b128 v[16:19], v2 offset:59392
  s_cmp_lt_u32 s3, 4
  s_cbranch_scc0 L_c4
  ds_read_b128 v[20:23], v3
  s_waitcnt lgkmcnt(0)
  buffer_store_dwordx4 v[20:23], v1, s[24:27], s54 offen sc1
L_c4:
  s_waitcnt lgkmcnt(3)
  buffer_store_dwordx4 v[4:7], v1, s[24:27], s50 offen sc1
  s_waitcnt lgkmcnt(2)
  buffer_store_dwordx4 v[8:11], v1, s[24:27], s51 offen sc1
  s_waitcnt lgkmcnt(1)
  buffer_store_dwordx4 v[12:15], v1, s[24:27], s52 offen sc1
  s_waitcnt lgkmcnt(0)
  buffer_store_dwordx4 v[16:19], v1, s[24:27], s53 offen sc1
  s_mov_b32 s63, s58
  v_mov_b32 v154, 149568
  v_mov_b32 v24, 1
  s_mov_b64 exec, 1
  ds_add_u32 v154, v24 offset:16
  s_mov_b64 exec, -1
L_att:
  s_and_b32 s31, s2, 7
  s_lshl_b32 s31, s31, 1
  s_bfe_u32 s32, s2, 0x10003
  s_add_u32 s31, s31, s32
  s_lshr_b32 s30, s31, 2
  s_lshr_b32 s32, s2, 4
  s_add_u32 s32, s32, 4
  s_and_b32 s32, s32, 15
  s_lshr_b32 s33, s2, 3
  s_mul_i32 s34, s33, 57
  s_lshr_b32 s34, s34, 9
  s_mul_i32 s53, s34, 9
  s_sub_u32 s53, s33, s53
  s_lshl_b32 s52, s34, 3
  s_and_b32 s34, s2, 7
  s_add_u32 s52, s52, s34
  s_sub_u32 s33, s2, 216
  s_mul_i32 s34, s33, 57
  s_lshr_b32 s34, s34, 9
  s_mul_i32 s35, s34, 9
  s_sub_u32 s33, s33, s35
  s_add_u32 s34, s34, 24
  s_cmp_ge_u32 s2, 216
  s_cselect_b32 s52, s34, s52
  s_cselect_b32 s53, s33, s53
  s_mul_i32 s33, s31, 147456
  s_mul_i32 s34, s32, 9216
  s_add_u32 s33, s33, s34
  v_mov_b32 v154, 149568
  s_lshl_b32 s34, s3, 10
  s_add_u32 s16, s34, 55296
  s_add_u32 s44, s33, 4294912000
  s_add_u32 s44, s44, s16
  s_mov_b32 s35, 63488
  s_mov_b32 s36, 4294912000
  s_cmp_ge_u32 s3, 1
  s_cselect_b32 s35, 4294966272, s35
  s_cselect_b32 s36, 2340864, s36
  s_add_u32 s17, s34, s35
  s_add_u32 s45, s33, s36
  s_add_u32 s45, s45, s17
  s_mov_b32 s35, 7168
  s_mov_b32 s36, 2340864
  s_cmp_ge_u32 s3, 2
  s_cselect_b32 s35, 25600, s35
  s_cselect_b32 s36, 4672512, s36
  s_add_u32 s18, s34, s35
  s_add_u32 s46, s33, s36
  s_add_u32 s46, s46, s18
  s_mov_b32 s35, 33792
  s_mov_b32 s36, 4672512
  s_cmp_ge_u32 s3, 3
  s_cselect_b32 s35, 6144, s35
  s_cselect_b32 s36, 2340864, s36
  s_add_u32 s19, s34, s35
  s_add_u32 s47, s33, s36
  s_add_u32 s47, s47, s19
  s_mov_b32 s35, 14336
  s_mov_b32 s36, 2340864
  s_cmp_ge_u32 s3, 4
  s_cselect_b32 s35, 32768, s35
  s_cselect_b32 s36, 4672512, s36
  s_add_u32 s20, s34, s35
  s_add_u32 s48, s33, s36
  s_add_u32 s48, s48, s20
  s_mov_b32 s35, 40960
  s_mov_b32 s36, 4672512
  s_cmp_ge_u32 s3, 5
  s_cselect_b32 s35, 13312, s35
  s_cselect_b32 s36, 2340864, s36
  s_add_u32 s21, s34, s35
  s_add_u32 s49, s33, s36
  s_add_u32 s49, s49, s21
  s_mov_b32 s35, 21504
  s_mov_b32 s36, 2340864
  s_cmp_ge_u32 s3, 6
  s_cselect_b32 s35, 39936, s35
  s_cselect_b32 s36, 4672512, s36
  s_add_u32 s22, s34, s35
  s_add_u32 s50, s33, s36
  s_add_u32 s50, s50, s22
  s_min_u32 s34, s34, 6144
  s_add_u32 s23, s34, 48128
  s_add_u32 s51, s33, 4672512
  s_add_u32 s51, s51, s23
  v_mov_b32 v10, s63
  v_mov_b32 v11, s65
  s_waitcnt vmcnt(0)
  v_mov_b32 v9, 1
  s_mov_b64 exec, 1
  ds_add_rtn_u32 v9, v154, v9 offset:40
  s_mov_b64 exec, -1
  s_cmp_lg_u32 s63, 0
  s_cselect_b32 s35, 7, 99
  s_waitcnt lgkmcnt(0)
  v_readfirstlane_b32 s36, v9
  s_nop 0
  s_cmp_eq_u32 s36, s35
  s_cbranch_scc0 L_nofl1
  s_mov_b64 exec, 1
  global_store_dword v10, v11, s[8:9] sc1
  s_mov_b64 exec, -1
L_nofl1:
  s_and_b32 s42, s3, 1
  s_lshr_b32 s43, s3, 1
  s_mul_i32 s35, s43, 2304
  s_mul_i32 s36, s42, 40
  v_and_b32 v112, 31, v0
  v_lshrrev_b32 v113, 5, v0
  v_mul_u32_u24 v2, 72, v112
  v_add_u32 v2, s35, v2
  v_lshl_add_u32 v1, v113, 4, v2
  v_add_u32 v1, s36, v1
  v_add_u32 v2, 32, v2
  v_bfe_u32 v114, v0, 2, 2
  v_lshl_add_u32 v114, v113, 2, v114
  v_mul_u32_u24 v114, 72, v114
  s_add_u32 s37, s35, 27648
  v_add_u32 v114, s37, v114
  v_and_b32 v115, 3, v0
  v_lshlrev_b32 v116, 3, v115
  v_add_u32 v116, s36, v116
  v_and_b32 v117, 16, v0
  v_cmp_eq_u32 s[38:39], 0, v117
  s_nop 1
  v_cndmask_b32 v116, 32, v116, s[38:39]
  v_add_u32 v3, v114, v116
  v_and_b32 v117, 19, v0
  v_cmp_lt_u32 s[38:39], 16, v117
  v_mov_b32 v118, 64512
  s_nop 0
  v_cndmask_b32 v3, v3, v118, s[38:39]
  v_mov_b32 v118, 2304
  v_cndmask_b32 v4, v118, 0, s[38:39]
  v_lshlrev_b32 v114, 2, v113
  v_sub_u32 v114, v112, v114
  v_mov_b32 v115, 0xffff
  v_cmp_le_i32 s[38:39], 0, v114
  v_cmp_le_i32 s[40:41], 1, v114
  s_nop 0
  v_cndmask_b32 v12, 0, v115, s[38:39]
  v_cndmask_b32 v12, v12, -1, s[40:41]
  v_cmp_le_i32 s[38:39], 2, v114
  v_cmp_le_i32 s[40:41], 3, v114
  s_nop 0
  v_cndmask_b32 v13, 0, v115, s[38:39]
  v_cndmask_b32 v13, v13, -1, s[40:41]
  v_cmp_le_i32 s[38:39], 8, v114
  v_cmp_le_i32 s[40:41], 9, v114
  s_nop 0
  v_cndmask_b32 v14, 0, v115, s[38:39]
  v_cndmask_b32 v14, v14, -1, s[40:41]
  v_cmp_le_i32 s[38:39], 10, v114
  v_cmp_le_i32 s[40:41], 11, v114
  s_nop 0
  v_cndmask_b32 v15, 0, v115, s[38:39]
  v_cndmask_b32 v15, v15, -1, s[40:41]
  v_cmp_le_i32 s[38:39], 16, v114
  v_cmp_le_i32 s[40:41], 17, v114
  s_nop 0
  v_cndmask_b32 v16, 0, v115, s[38:39]
  v_cndmask_b32 v16, v16, -1, s[40:41]
  v_cmp_le_i32 s[38:39], 18, v114
  v_cmp_le_i32 s[40:41], 19, v114
  s_nop 0
  v_cndmask_b32 v17, 0, v115, s[38:39]
  v_cndmask_b32 v17, v17, -1, s[40:41]
  v_cmp_le_i32 s[38:39], 24, v114
  v_cmp_le_i32 s[40:41], 25, v114
  s_nop 0
  v_cndmask_b32 v18, 0, v115, s[38:39]
  v_cndmask_b32 v18, v18, -1, s[40:41]
  v_cmp_le_i32 s[38:39], 26, v114
  v_cmp_le_i32 s[40:41], 27, v114
  s_nop 0
  v_cndmask_b32 v19, 0, v115, s[38:39]
  v_cndmask_b32 v19, v19, -1, s[40:41]
  s_lshl_b32 s41, s32, 2
  s_add_u32 s41, s41, s43
  s_sub_i32 s41, 8, s41
  s_lshl_b32 s35, s32, 3
  s_lshl_b32 s36, s43, 1
  s_add_u32 s35, s35, s36
  s_mul_i32 s35, s35, 18432
  s_lshl_b32 s58, s31, 10
  s_lshl_b32 s36, s42, 9
  s_add_u32 s58, s58, s36
  s_add_u32 s58, s58, s35
  s_lshr_b32 s59, s31, 1
  s_lshl_b32 s59, s59, 8
  s_and_b32 s36, s31, 1
  s_lshl_b32 s36, s36, 3
  s_add_u32 s59, s59, s36
  s_lshl_b32 s36, s42, 2
  s_add_u32 s59, s59, s36
  s_add_u32 s59, s59, s35
  s_add_u32 s59, s59, 16384
  v_bfe_u32 v152, v0, 4, 1
  v_mul_u32_u24 v152, 18432, v152
  v_and_b32 v153, 15, v0
  v_lshl_add_u32 v152, v153, 4, v152
  v_lshrrev_b32 v153, 5, v0
  v_lshl_add_u32 v153, v153, 8, v152
  v_cmp_gt_u32 vcc, 32, v0
  s_cmp_eq_u32 s42, 0
  s_cselect_b64 s[54:55], vcc, 0
  s_cselect_b64 s[56:57], 0, vcc
  v_and_b32 v114, 3, v0
  v_mul_u32_u24 v114, 576, v114
  v_mov_b32 v116, 0x3f803f80
  v_mov_b32 v117, v116
  v_lshlrev_b32 v115, 4, v0
  s_add_u32 s36, s8, 0
  s_addc_u32 s37, s9, 0
  s_and_b32 s37, s37, 0xffff
  s_mov_b32 s38, 7077888
  s_mov_b32 s39, 0x20000
  s_add_u32 s24, s8, 7340032
  s_addc_u32 s25, s9, 0
  s_and_b32 s25, s25, 0xffff
  s_mov_b32 s26, 2359296
  s_mov_b32 s27, 0x20000
  s_add_u32 s40, s3, 2
  s_cmp_lt_u32 s3, 4
  s_cselect_b32 s40, s3, s40
  s_and_b32 s6, s40, 1
  s_lshr_b32 s7, s40, 1
  s_mul_i32 s13, s52, 5
  s_and_b32 s33, s13, 7
  s_sub_u32 s34, 8, s33
  s_cmp_lt_u32 s33, 4
  s_cselect_b32 s34, 0, s34
  s_add_u32 s34, s34, s7
  s_sub_u32 s35, s34, 5
  s_cmp_ge_u32 s34, 5
  s_cselect_b32 s34, s35, s34
  s_add_u32 s13, s13, s34
  s_lshl_b32 s98, s34, 6
  s_mov_b32 s14, 0x404
  s_bitcmp1_b32 s13, 2
  s_mov_b32 s15, 55296
  s_cmp_eq_u32 s7, 1
  s_cselect_b32 s15, 59392, s15
  s_cmp_eq_u32 s7, 2
  s_cselect_b32 s15, 140288, s15
  s_cmp_eq_u32 s7, 3
  s_cselect_b32 s15, 144384, s15
  s_cmp_eq_u32 s7, 4
  s_cselect_b32 s15, 158208, s15
  s_mul_i32 s28, s13, 18432
  s_lshl_b32 s33, s53, 7
  s_add_u32 s29, s28, s33
  s_lshl_b32 s33, s6, 6
  s_add_u32 s29, s29, s33
  s_mul_i32 s33, s6, 9216
  s_add_u32 s28, s28, s33
  s_add_u32 s96, s28, 4096
  s_add_u32 s97, s28, 8192
  v_lshrrev_b32 v140, 2, v0
  v_and_b32 v141, 3, v0
  v_mul_u32_u24 v142, 1152, v140
  v_lshl_add_u32 v142, v141, 4, v142
  v_lshrrev_b32 v146, 2, v0
  v_bfe_u32 v147, v0, 3, 2
  v_lshlrev_b32 v147, 1, v147
  v_bfe_u32 v148, v0, 1, 1
  v_xor_b32 v147, v147, v148
  v_and_b32 v148, 1, v0
  v_lshlrev_b32 v148, 3, v148
  v_lshl_add_u32 v148, v146, 7, v148
  v_lshl_add_u32 v148, v147, 4, v148
  s_mul_i32 s33, s6, 36864
  s_add_u32 s33, s33, 66560
  s_lshl_b32 s34, s6, 6
  v_xor_b32 v148, s34, v148
  v_xor_b32 v156, 0, v148
  v_add_u32 v156, s33, v156
  v_xor_b32 v157, 32, v148
  v_add_u32 v157, s33, v157
  v_xor_b32 v158, 64, v148
  v_add_u32 v158, s33, v158
  v_xor_b32 v159, 96, v148
  v_add_u32 v159, s33, v159
  v_lshlrev_b32 v162, 4, v0
  s_lshl_b32 s33, s6, 11
  s_add_u32 s15, s15, s33
  v_add_u32 v160, s15, v162
  s_lshl_b32 s33, s33, 1
  s_sub_u32 s33, 2048, s33
  v_add_u32 v164, s33, v160
  s_lshl_b32 s33, s7, 1
  s_add_u32 s33, s33, s6
  s_lshl_b32 s33, s33, 2
  s_add_u32 s33, s33, 149568
  v_mov_b32 v161, s33
  v_xor_b32 v165, 4, v161
  v_and_b32 v143, 15, v0
  v_mul_u32_u24 v143, 80, v143
  v_lshrrev_b32 v146, 4, v0
  v_lshlrev_b32 v146, 3, v146
  v_add3_u32 v143, v143, v146, s15
  v_mul_u32_u24 v144, 80, v140
  v_lshl_add_u32 v144, v141, 4, v144
  v_add_u32 v144, s15, v144
  s_add_u32 s98, s98, 154624
  v_lshl_add_u32 v145, v140, 2, s98
  s_cmp_lt_u32 s3, 4
  s_cselect_b32 s33, 1, 0x100
  v_mov_b32 v163, s33
  s_lshr_b32 s35, s2, 6
  s_lshl_b32 s35, s35, 4
  s_add_u32 s35, s35, s3
  s_cmp_eq_u32 s35, 54
  s_cbranch_scc0 L_nq2
  s_mov_b32 s60, 0x200000
L_sp_x6:
  ds_read_b32 v120, v154 offset:72
  s_waitcnt lgkmcnt(0)
  v_readfirstlane_b32 s61, v120
  s_nop 0
  s_cmp_eq_u32 s61, 1
  s_cbranch_scc1 L_sp_x6_d
  s_sleep 8
  s_sub_u32 s60, s60, 1
  s_cmp_lg_u32 s60, 0
  s_cbranch_scc1 L_sp_x6
L_sp_x6_d:
  v_add_u32 v120, 2, v0
  v_mul_u32_u24 v121, 43, v120
  v_lshrrev_b32 v121, 7, v121
  v_mul_u32_u24 v122, 3, v121
  v_sub_u32 v120, v120, v122
  s_sub_u32 s35, s32, 2
  v_add_u32 v120, s35, v120
  v_max_i32 v120, 0, v120
  v_mul_u32_u24 v120, 12, v120
  v_lshl_add_u32 v120, v121, 2, v120
  v_add_u32 v120, s30, v120
  v_lshlrev_b32 v120, 7, v120
  v_add_u32 v120, 10223616, v120
  s_mov_b64 exec, 0x7f
  s_mov_b32 s60, 0x40000
L_qp2:
  global_load_dword v121, v120, s[8:9] sc1
  s_waitcnt vmcnt(0)
  v_cmp_eq_u32 vcc, s65, v121
  s_nop 0
  s_cmp_eq_u64 vcc, exec
  s_cbranch_scc1 L_qp2_d
  s_sub_u32 s60, s60, 1
  s_cmp_lg_u32 s60, 0
  s_cbranch_scc1 L_qp2
L_qp2_d:
  s_mov_b64 exec, -1
  v_mov_b32 v122, 1
  s_mov_b64 exec, 1
  ds_add_u32 v154, v122 offset:44
  s_mov_b64 exec, -1
L_nq2:
  s_mov_b32 s60, 0x200000
L_go1:
  ds_read_b64 v[112:113], v154 offset:40
  s_waitcnt lgkmcnt(0)
  v_readfirstlane_b32 s61, v112
  v_readfirstlane_b32 s62, v113
  s_nop 0
  s_lshl_b32 s62, s62, 8
  s_or_b32 s61, s61, s62
  s_cmp_eq_u32 s61, 264
  s_cbranch_scc1 L_go1_d
  s_sleep 1
  s_sub_u32 s60, s60, 1
  s_cmp_lg_u32 s60, 0
  s_cbranch_scc1 L_go1
L_go1_d:
  s_mov_b32 m0, s16
  s_nop 0
  buffer_load_dwordx4 v115, s[36:39], s44 offen sc1 lds
  s_mov_b32 m0, s17
  s_nop 0
  buffer_load_dwordx4 v115, s[36:39], s45 offen sc1 lds
  s_mov_b32 m0, s18
  s_nop 0
  buffer_load_dwordx4 v115, s[36:39], s46 offen sc1 lds
  s_mov_b32 m0, s19
  s_nop 0
  buffer_load_dwordx4 v115, s[36:39], s47 offen sc1 lds
  s_mov_b32 m0, s20
  s_nop 0
  buffer_load_dwordx4 v115, s[36:39], s48 offen sc1 lds
  s_mov_b32 m0, s21
  s_nop 0
  buffer_load_dwordx4 v115, s[36:39], s49 offen sc1 lds
  s_mov_b32 m0, s22
  s_nop 0
  buffer_load_dwordx4 v115, s[36:39], s50 offen sc1 lds
  s_mov_b32 m0, s23
  s_nop 0
  buffer_load_dwordx4 v115, s[36:39], s51 offen sc1 lds
  ds_write_b64 v114, v[116:117] offset:64512
  s_cmp_lt_u32 s32, 2
  s_cbranch_scc1 L_late
  v_mov_b32 v112, 0x1
  s_waitcnt vmcnt(0)
  s_mov_b64 exec, 1
  ds_add_u32 v154, v112 offset:8
  s_mov_b64 exec, -1
  s_mov_b32 s60, 0x200000
L_sA:
  ds_read_b32 v112, v154 offset:8
  s_waitcnt lgkmcnt(0)
  v_readfirstlane_b32 s61, v112
  s_nop 0
  s_bitcmp1_b32 s61, 3
  s_cbranch_scc1 L_sA_d
  s_sub_u32 s60, s60, 1
  s_cmp_lg_u32 s60, 0
  s_cbranch_scc1 L_sA
L_sA_d:
  ds_read_b64 v[6:7], v1 offset:55296
  ds_read_b64 v[8:9], v1 offset:55304
  ds_read_b64 v[10:11], v2 offset:55296
  ds_read_b64 v[20:21], v1 offset:0
  ds_read_b64 v[22:23], v1 offset:8
  ds_read_b64 v[24:25], v2 offset:0
  ds_read_b64 v[26:27], v1 offset:2304
  ds_read_b64 v[28:29], v1 offset:2312
  ds_read_b64 v[30:31], v2 offset:2304
  ds_read_b64_tr_b16 v[32:33], v3 offset:0
  ds_read_b64_tr_b16 v[34:35], v3 offset:576
  ds_read_b64_tr_b16 v[36:37], v3 offset:1152
  ds_read_b64_tr_b16 v[38:39], v3 offset:1728
  s_waitcnt lgkmcnt(7)
  v_cndmask_b32 v10, 0, v10, s[54:55]
  v_cndmask_b32 v11, 0, v11, s[56:57]
  v_mfma_f32_32x32x16_bf16 v[64:79], v[20:23], v[6:9], 0
  s_nop 0
  v_mfma_f32_32x32x8_bf16 v[64:79], v[24:25], v[10:11], v[64:79]
  v_mov_b32 v112, 1
  s_mov_b64 exec, 1
  ds_add_u32 v154, v112 offset:36
  s_mov_b64 exec, -1
  s_mov_b32 s20, s4
  s_and_b32 s21, s5, 0xffff
  s_mov_b32 s22, 2359296
  s_mov_b32 s23, 0x20000
  buffer_load_dwordx4 v[128:131], v142, s[20:23], s29 offen
  s_cmp_lt_u32 s3, 4
  s_cbranch_scc1 L_bal0
  s_setprio 1
L_bal0:
L_it0:
  s_waitcnt lgkmcnt(0)
  v_mfma_f32_32x32x16_bf16 v[80:95], v[26:29], v[6:9], 0
  v_exp_f32 v64, v64
  v_exp_f32 v65, v65
  v_exp_f32 v66, v66
  v_exp_f32 v67, v67
  v_mfma_f32_32x32x8_bf16 v[80:95], v[30:31], v[10:11], v[80:95]
  ds_read_b64 v[20:21], v1 offset:4608
  ds_read_b64 v[22:23], v1 offset:4616
  ds_read_b64 v[24:25], v2 offset:4608
  v_exp_f32 v68, v68
  v_exp_f32 v69, v69
  v_exp_f32 v70, v70
  v_exp_f32 v71, v71
  v_cvt_pk_bf16_f32 v48, v64, v65
  v_cvt_pk_bf16_f32 v49, v66, v67
  v_exp_f32 v72, v72
  v_exp_f32 v73, v73
  v_exp_f32 v74, v74
  v_exp_f32 v75, v75
  v_cvt_pk_bf16_f32 v50, v68, v69
  v_cvt_pk_bf16_f32 v51, v70, v71
  v_add_u32 v3, v3, v4
  ds_read_b64_tr_b16 v[40:41], v3 offset:0
  ds_read_b64_tr_b16 v[42:43], v3 offset:576
  ds_read_b64_tr_b16 v[44:45], v3 offset:1152
  ds_read_b64_tr_b16 v[46:47], v3 offset:1728
  v_exp_f32 v76, v76
  v_exp_f32 v77, v77
  v_exp_f32 v78, v78
  v_exp_f32 v79, v79
  v_cvt_pk_bf16_f32 v52, v72, v73
  v_cvt_pk_bf16_f32 v53, v74, v75
  v_cvt_pk_bf16_f32 v54, v76, v77
  v_cvt_pk_bf16_f32 v55, v78, v79
  v_bfi_b32 v48, v12, 0, v48
  v_bfi_b32 v49, v13, 0, v49
  v_bfi_b32 v50, v14, 0, v50
  v_bfi_b32 v51, v15, 0, v51
  v_bfi_b32 v52, v16, 0, v52
  v_bfi_b32 v53, v17, 0, v53
  v_bfi_b32 v54, v18, 0, v54
  v_bfi_b32 v55, v19, 0, v55
L_it1:
  s_waitcnt lgkmcnt(4)
  v_mfma_f32_32x32x16_bf16 v[64:79], v[20:23], v[6:9], 0
  v_exp_f32 v80, v80
  v_exp_f32 v81, v81
  v_exp_f32 v82, v82
  v_exp_f32 v83, v83
  v_mfma_f32_32x32x8_bf16 v[64:79], v[24:25], v[10:11], v[64:79]
  ds_read_b64 v[26:27], v1 offset:6912
  ds_read_b64 v[28:29], v1 offset:6920
  ds_read_b64 v[30:31], v2 offset:6912
  v_exp_f32 v84, v84
  v_exp_f32 v85, v85
  v_exp_f32 v86, v86
  v_exp_f32 v87, v87
  v_cvt_pk_bf16_f32 v56, v80, v81
  v_cvt_pk_bf16_f32 v57, v82, v83
  v_mfma_f32_32x32x16_bf16 v[96:111], v[32:35], v[48:51], 0
  v_exp_f32 v88, v88
  v_exp_f32 v89, v89
  v_exp_f32 v90, v90
  v_exp_f32 v91, v91
  v_cvt_pk_bf16_f32 v58, v84, v85
  v_cvt_pk_bf16_f32 v59, v86, v87
  v_mfma_f32_32x32x16_bf16 v[96:111], v[36:39], v[52:55], v[96:111]
  v_add_u32 v3, v3, v4
  ds_read_b64_tr_b16 v[32:33], v3 offset:0
  ds_read_b64_tr_b16 v[34:35], v3 offset:576
  ds_read_b64_tr_b16 v[36:37], v3 offset:1152
  ds_read_b64_tr_b16 v[38:39], v3 offset:1728
  v_exp_f32 v92, v92
  v_exp_f32 v93, v93
  v_exp_f32 v94, v94
  v_exp_f32 v95, v95
  v_cvt_pk_bf16_f32 v60, v88, v89
  v_cvt_pk_bf16_f32 v61, v90, v91
  v_cvt_pk_bf16_f32 v62, v92, v93
  v_cvt_pk_bf16_f32 v63, v94, v95
L_it2:
  s_waitcnt lgkmcnt(4)
  v_mfma_f32_32x32x16_bf16 v[80:95], v[26:29], v[6:9], 0
  v_exp_f32 v64, v64
  v_exp_f32 v65, v65
  v_exp_f32 v66, v66
  v_exp_f32 v67, v67
  v_mfma_f32_32x32x8_bf16 v[80:95], v[30:31], v[10:11], v[80:95]
  ds_read_b64 v[20:21], v1 offset:9216
  ds_read_b64 v[22:23], v1 offset:9224
  ds_read_b64 v[24:25], v2 offset:9216
  v_exp_f32 v68, v68
  v_exp_f32 v69, v69
  v_exp_f32 v70, v70
  v_exp_f32 v71, v71
  v_cvt_pk_bf16_f32 v48, v64, v65
  v_cvt_pk_bf16_f32 v49, v66, v67
  v_mfma_f32_32x32x16_bf16 v[96:111], v[40:43], v[56:59], v[96:111]
  v_exp_f32 v72, v72
  v_exp_f32 v73, v73
  v_exp_f32 v74, v74
  v_exp_f32 v75, v75
  v_cvt_pk_bf16_f32 v50, v68, v69
  v_cvt_pk_bf16_f32 v51, v70, v71
  v_mfma_f32_32x32x16_bf16 v[96:111], v[44:47], v[60:63], v[96:111]
  v_add_u32 v3, v3, v4
  ds_read_b64_tr_b16 v[40:41], v3 offset:0
  ds_read_b64_tr_b16 v[42:43], v3 offset:576
  ds_read_b64_tr_b16 v[44:45], v3 offset:1152
  ds_read_b64_tr_b16 v[46:47], v3 offset:1728
  v_exp_f32 v76, v76
  v_exp_f32 v77, v77
  v_exp_f32 v78, v78
  v_exp_f32 v79, v79
  v_cvt_pk_bf16_f32 v52, v72, v73
  v_cvt_pk_bf16_f32 v53, v74, v75
  v_cvt_pk_bf16_f32 v54, v76, v77
  v_cvt_pk_bf16_f32 v55, v78, v79
L_it3:
  s_waitcnt lgkmcnt(4)
  v_mfma_f32_32x32x16_bf16 v[64:79], v[20:23], v[6:9], 0
  v_exp_f32 v80, v80
  v_exp_f32 v81, v81
  v_exp_f32 v82, v82
  v_exp_f32 v83, v83
  v_mfma_f32_32x32x8_bf16 v[64:79], v[24:25], v[10:11], v[64:79]
  ds_read_b64 v[26:27], v1 offset:11520
  ds_read_b64 v[28:29], v1 offset:11528
  ds_read_b64 v[30:31], v2 offset:11520
  v_exp_f32 v84, v84
  v_exp_f32 v85, v85
  v_exp_f32 v86, v86
  v_exp_f32 v87, v87
  v_cvt_pk_bf16_f32 v56, v80, v81
  v_cvt_pk_bf16_f32 v57, v82, v83
  v_mfma_f32_32x32x16_bf16 v[96:111], v[32:35], v[48:51], v[96:111]
  v_exp_f32 v88, v88
  v_exp_f32 v89, v89
  v_exp_f32 v90, v90
  v_exp_f32 v91, v91
  v_cvt_pk_bf16_f32 v58, v84, v85
  v_cvt_pk_bf16_f32 v59, v86, v87
  v_mfma_f32_32x32x16_bf16 v[96:111], v[36:39], v[52:55], v[96:111]
  v_add_u32 v3, v3, v4
  ds_read_b64_tr_b16 v[32:33], v3 offset:0
  ds_read_b64_tr_b16 v[34:35], v3 offset:576
  ds_read_b64_tr_b16 v[36:37], v3 offset:1152
  ds_read_b64_tr_b16 v[38:39], v3 offset:1728
  v_exp_f32 v92, v92
  v_exp_f32 v93, v93
  v_exp_f32 v94, v94
  v_exp_f32 v95, v95
  v_cvt_pk_bf16_f32 v60, v88, v89
  v_cvt_pk_bf16_f32 v61, v90, v91
  v_cvt_pk_bf16_f32 v62, v92, v93
  v_cvt_pk_bf16_f32 v63, v94, v95
  s_setprio 0
L_it4:
  s_waitcnt lgkmcnt(4)
  v_mfma_f32_32x32x16_bf16 v[80:95], v[26:29], v[6:9], 0
  v_exp_f32 v64, v64
  v_exp_f32 v65, v65
  v_exp_f32 v66, v66
  v_exp_f32 v67, v67
  v_mfma_f32_32x32x8_bf16 v[80:95], v[30:31], v[10:11], v[80:95]
  ds_read_b64 v[20:21], v1 offset:13824
  ds_read_b64 v[22:23], v1 offset:13832
  ds_read_b64 v[24:25], v2 offset:13824
  v_exp_f32 v68, v68
  v_exp_f32 v69, v69
  v_exp_f32 v70, v70
  v_exp_f32 v71, v71
  v_cvt_pk_bf16_f32 v48, v64, v65
  v_cvt_pk_bf16_f32 v49, v66, v67
  v_mfma_f32_32x32x16_bf16 v[96:111], v[40:43], v[56:59], v[96:111]
  v_exp_f32 v72, v72
  v_exp_f32 v73, v73
  v_exp_f32 v74, v74
  v_exp_f32 v75, v75
  v_cvt_pk_bf16_f32 v50, v68, v69
  v_cvt_pk_bf16_f32 v51, v70, v71
  v_mfma_f32_32x32x16_bf16 v[96:111], v[44:47], v[60:63], v[96:111]
  v_add_u32 v3, v3, v4
  ds_read_b64_tr_b16 v[40:41], v3 offset:0
  ds_read_b64_tr_b16 v[42:43], v3 offset:576
  ds_read_b64_tr_b16 v[44:45], v3 offset:1152
  ds_read_b64_tr_b16 v[46:47], v3 offset:1728
  v_exp_f32 v76, v76
  v_exp_f32 v77, v77
  v_exp_f32 v78, v78
  v_exp_f32 v79, v79
  v_cvt_pk_bf16_f32 v52, v72, v73
  v_cvt_pk_bf16_f32 v53, v74, v75
  v_cvt_pk_bf16_f32 v54, v76, v77
  v_cvt_pk_bf16_f32 v55, v78, v79
L_it5:
  s_waitcnt lgkmcnt(4)
  v_mfma_f32_32x32x16_bf16 v[64:79], v[20:23], v[6:9], 0
  v_exp_f32 v80, v80
  v_exp_f32 v81, v81
  v_exp_f32 v82, v82
  v_exp_f32 v83, v83
  v_mfma_f32_32x32x8_bf16 v[64:79], v[24:25], v[10:11], v[64:79]
  ds_read_b64 v[26:27], v1 offset:16128
  ds_read_b64 v[28:29], v1 offset:16136
  ds_read_b64 v[30:31], v2 offset:16128
  v_exp_f32 v84, v84
  v_exp_f32 v85, v85
  v_exp_f32 v86, v86
  v_exp_f32 v87, v87
  v_cvt_pk_bf16_f32 v56, v80, v81
  v_cvt_pk_bf16_f32 v57, v82, v83
  v_mfma_f32_32x32x16_bf16 v[96:111], v[32:35], v[48:51], v[96:111]
  v_exp_f32 v88, v88
  v_exp_f32 v89, v89
  v_exp_f32 v90, v90
  v_exp_f32 v91, v91
  v_cvt_pk_bf16_f32 v58, v84, v85
  v_cvt_pk_bf16_f32 v59, v86, v87
  v_mfma_f32_32x32x16_bf16 v[96:111], v[36:39], v[52:55], v[96:111]
  v_add_u32 v3, v3, v4
  ds_read_b64_tr_b16 v[32:33], v3 offset:0
  ds_read_b64_tr_b16 v[34:35], v3 offset:576
  ds_read_b64_tr_b16 v[36:37], v3 offset:1152
  ds_read_b64_tr_b16 v[38:39], v3 offset:1728
  v_exp_f32 v92, v92
  v_exp_f32 v93, v93
  v_exp_f32 v94, v94
  v_exp_f32 v95, v95
  v_cvt_pk_bf16_f32 v60, v88, v89
  v_cvt_pk_bf16_f32 v61, v90, v91
  v_cvt_pk_bf16_f32 v62, v92, v93
  v_cvt_pk_bf16_f32 v63, v94, v95
L_it6:
  s_waitcnt lgkmcnt(4)
  v_mfma_f32_32x32x16_bf16 v[80:95], v[26:29], v[6:9], 0
  v_exp_f32 v64, v64
  v_exp_f32 v65, v65
  v_exp_f32 v66, v66
  v_exp_f32 v67, v67
  v_mfma_f32_32x32x8_bf16 v[80:95], v[30:31], v[10:11], v[80:95]
  ds_read_b64 v[20:21], v1 offset:18432
  ds_read_b64 v[22:23], v1 offset:18440
  ds_read_b64 v[24:25], v2 offset:18432
  v_exp_f32 v68, v68
  v_exp_f32 v69, v69
  v_exp_f32 v70, v70
  v_exp_f32 v71, v71
  v_cvt_pk_bf16_f32 v48, v64, v65
  v_cvt_pk_bf16_f32 v49, v66, v67
  v_mfma_f32_32x32x16_bf16 v[96:111], v[40:43], v[56:59], v[96:111]
  v_exp_f32 v72, v72
  v_exp_f32 v73, v73
  v_exp_f32 v74, v74
  v_exp_f32 v75, v75
  v_cvt_pk_bf16_f32 v50, v68, v69
  v_cvt_pk_bf16_f32 v51, v70, v71
  v_mfma_f32_32x32x16_bf16 v[96:111], v[44:47], v[60:63], v[96:111]
  v_add_u32 v3, v3, v4
  ds_read_b64_tr_b16 v[40:41], v3 offset:0
  ds_read_b64_tr_b16 v[42:43], v3 offset:576
  ds_read_b64_tr_b16 v[44:45], v3 offset:1152
  ds_read_b64_tr_b16 v[46:47], v3 offset:1728
  v_exp_f32 v76, v76
  v_exp_f32 v77, v77
  v_exp_f32 v78, v78
  v_exp_f32 v79, v79
  v_cvt_pk_bf16_f32 v52, v72, v73
  v_cvt_pk_bf16_f32 v53, v74, v75
  v_cvt_pk_bf16_f32 v54, v76, v77
  v_cvt_pk_bf16_f32 v55, v78, v79
L_it7:
  s_waitcnt lgkmcnt(4)
  v_mfma_f32_32x32x16_bf16 v[64:79], v[20:23], v[6:9], 0
  v_exp_f32 v80, v80
  v_exp_f32 v81, v81
  v_exp_f32 v82, v82
  v_exp_f32 v83, v83
  v_mfma_f32_32x32x8_bf16 v[64:79], v[24:25], v[10:11], v[64:79]
  v_exp_f32 v84, v84
  v_exp_f32 v85, v85
  v_exp_f32 v86, v86
  v_exp_f32 v87, v87
  v_cvt_pk_bf16_f32 v56, v80, v81
  v_cvt_pk_bf16_f32 v57, v82, v83
  v_mfma_f32_32x32x16_bf16 v[96:111], v[32:35], v[48:51], v[96:111]
  v_exp_f32 v88, v88
  v_exp_f32 v89, v89
  v_exp_f32 v90, v90
  v_exp_f32 v91, v91
  v_cvt_pk_bf16_f32 v58, v84, v85
  v_cvt_pk_bf16_f32 v59, v86, v87
  v_mfma_f32_32x32x16_bf16 v[96:111], v[36:39], v[52:55], v[96:111]
  v_add_u32 v3, v3, v4
  ds_read_b64_tr_b16 v[32:33], v3 offset:0
  ds_read_b64_tr_b16 v[34:35], v3 offset:576
  ds_read_b64_tr_b16 v[36:37], v3 offset:1152
  ds_read_b64_tr_b16 v[38:39], v3 offset:1728
  v_exp_f32 v92, v92
  v_exp_f32 v93, v93
  v_exp_f32 v94, v94
  v_exp_f32 v95, v95
  v_cvt_pk_bf16_f32 v60, v88, v89
  v_cvt_pk_bf16_f32 v61, v90, v91
  v_cvt_pk_bf16_f32 v62, v92, v93
  v_cvt_pk_bf16_f32 v63, v94, v95
L_it8:
  s_waitcnt lgkmcnt(0)
  v_exp_f32 v64, v64
  v_exp_f32 v65, v65
  v_exp_f32 v66, v66
  v_exp_f32 v67, v67
  v_exp_f32 v68, v68
  v_exp_f32 v69, v69
  v_exp_f32 v70, v70
  v_exp_f32 v71, v71
  v_cvt_pk_bf16_f32 v48, v64, v65
  v_cvt_pk_bf16_f32 v49, v66, v67
  v_mfma_f32_32x32x16_bf16 v[96:111], v[40:43], v[56:59], v[96:111]
  v_exp_f32 v72, v72
  v_exp_f32 v73, v73
  v_exp_f32 v74, v74
  v_exp_f32 v75, v75
  v_cvt_pk_bf16_f32 v50, v68, v69
  v_cvt_pk_bf16_f32 v51, v70, v71
  v_mfma_f32_32x32x16_bf16 v[96:111], v[44:47], v[60:63], v[96:111]
  v_exp_f32 v76, v76
  v_exp_f32 v77, v77
  v_exp_f32 v78, v78
  v_exp_f32 v79, v79
  v_cvt_pk_bf16_f32 v52, v72, v73
  v_cvt_pk_bf16_f32 v53, v74, v75
  v_cvt_pk_bf16_f32 v54, v76, v77
  v_cvt_pk_bf16_f32 v55, v78, v79
  v_and_b32 v48, v12, v48
  v_and_b32 v49, v13, v49
  v_and_b32 v50, v14, v50
  v_and_b32 v51, v15, v51
  v_and_b32 v52, v16, v52
  v_and_b32 v53, v17, v53
  v_and_b32 v54, v18, v54
  v_and_b32 v55, v19, v55
  s_mov_b32 s60, 0x200000
L_pz:
  ds_read_b32 v112, v154 offset:48
  s_waitcnt lgkmcnt(0)
  v_readfirstlane_b32 s61, v112
  s_nop 0
  s_cmp_eq_u32 s61, 1
  s_cbranch_scc1 L_pz_d
  s_sub_u32 s60, s60, 1
  s_cmp_lg_u32 s60, 0
  s_cbranch_scc1 L_pz
L_pz_d:
  v_mfma_f32_32x32x16_bf16 v[96:111], v[32:35], v[48:51], v[96:111]
  v_mfma_f32_32x32x16_bf16 v[96:111], v[36:39], v[52:55], v[96:111]
L_check:
  s_mov_b32 s46, 0x5d800000
  s_mov_b32 s47, 0x21800000
  s_mov_b32 s48, 0x7f800000
  s_nop 7
  s_nop 0
  v_rcp_f32 v112, v108
  v_cmp_gt_f32 s[50:51], s46, v108
  v_cmp_lt_f32 vcc, s47, v108
  v_add_f32 v114, abs(v96), abs(v97)
  v_add_f32 v115, abs(v98), abs(v99)
  v_add_f32 v116, abs(v100), abs(v101)
  v_add_f32 v117, abs(v102), abs(v103)
  v_add_f32 v118, abs(v104), abs(v105)
  v_add_f32 v119, abs(v106), abs(v107)
  s_and_b64 s[50:51], s[50:51], vcc
  v_pk_add_f32 v[114:115], v[114:115], v[116:117]
  v_pk_add_f32 v[114:115], v[114:115], v[118:119]
  v_add_f32 v114, v114, v115
  v_cmp_gt_f32 vcc, s48, v114
  s_nop 0
  s_and_b64 s[50:51], s[50:51], vcc
  s_cmp_eq_u64 s[50:51], -1
  s_cbranch_scc0 L_slow
L_fin:
  s_cmp_eq_u32 s42, 0
  s_cbranch_scc1 L_fa
  v_mov_b32 v104, v106
  v_mov_b32 v105, v107
L_fa:
  v_pk_mul_f32 v[96:97], v[96:97], v[112:113] op_sel_hi:[1,0]
  v_pk_mul_f32 v[98:99], v[98:99], v[112:113] op_sel_hi:[1,0]
  v_pk_mul_f32 v[100:101], v[100:101], v[112:113] op_sel_hi:[1,0]
  v_pk_mul_f32 v[102:103], v[102:103], v[112:113] op_sel_hi:[1,0]
  v_pk_mul_f32 v[104:105], v[104:105], v[112:113] op_sel_hi:[1,0]
  v_cvt_pk_bf16_f32 v116, v96, v97
  v_cvt_pk_bf16_f32 v117, v98, v99
  v_cvt_pk_bf16_f32 v118, v100, v101
  v_cvt_pk_bf16_f32 v119, v102, v103
  v_cvt_pk_bf16_f32 v120, v104, v105
  buffer_store_dwordx4 v[116:119], v153, s[24:27], s58 offen sc1
  s_mov_b32 exec_hi, 0
  buffer_store_dword v120, v152, s[24:27], s59 offen sc1
  s_mov_b32 exec_hi, -1
  s_cmp_ge_u32 s52, 26
  s_cbranch_scc1 L_end
  s_mov_b64 exec, 1
  ds_add_u32 v154, v163 offset:0
  s_mov_b64 exec, -1
L_out:
  s_mov_b32 s60, 0x200000
L_wo:
  ds_read_b32 v10, v154 offset:12
  s_waitcnt lgkmcnt(0)
  v_readfirstlane_b32 s61, v10
  s_nop 0
  s_cmp_eq_u32 s61, 2
  s_cbranch_scc1 L_wo_d
  s_sub_u32 s60, s60, 1
  s_cmp_lg_u32 s60, 0
  s_cbranch_scc1 L_wo
L_wo_d:
  ds_read_b64_tr_b16 v[20:21], v156 offset:0
  ds_read_b64_tr_b16 v[22:23], v156 offset:2048
  ds_read_b64_tr_b16 v[24:25], v157 offset:0
  ds_read_b64_tr_b16 v[26:27], v157 offset:2048
  ds_read_b64_tr_b16 v[28:29], v158 offset:0
  ds_read_b64_tr_b16 v[30:31], v158 offset:2048
  ds_read_b64_tr_b16 v[32:33], v159 offset:0
  ds_read_b64_tr_b16 v[34:35], v159 offset:2048
  ds_read_b64_tr_b16 v[36:37], v156 offset:4096
  ds_read_b64_tr_b16 v[38:39], v156 offset:6144
  ds_read_b64_tr_b16 v[40:41], v157 offset:4096
  ds_read_b64_tr_b16 v[42:43], v157 offset:6144
  ds_read_b64_tr_b16 v[44:45], v158 offset:4096
  ds_read_b64_tr_b16 v[46:47], v158 offset:6144
  ds_read_b64_tr_b16 v[48:49], v159 offset:4096
  ds_read_b64_tr_b16 v[50:51], v159 offset:6144
  s_mov_b32 s60, 0x200000
L_go2:
  ds_read_b64 v[10:11], v154 offset:0
  s_waitcnt lgkmcnt(0)
  v_readfirstlane_b32 s61, v10
  v_readfirstlane_b32 s62, v11
  s_and_b32 s61, s61, s14
  s_cmp_eq_u32 s61, s14
  s_cselect_b32 s62, s62, 0
  s_cmp_eq_u32 s62, 1
  s_cbranch_scc1 L_go2_d
  s_sub_u32 s60, s60, 1
  s_cbranch_scc0 L_go2
L_go2_d:
  s_cmp_eq_u32 s60, 0x200000
  s_cbranch_scc1 L_go2_e
  s_sleep 6
L_go2_e:
  s_waitcnt vmcnt(0)
  s_mov_b32 s60, 0x8000
  buffer_load_dwordx4 v[64:67], v162, s[24:27], s28 offen offset:0 sc1
  buffer_load_dwordx4 v[68:71], v162, s[24:27], s28 offen offset:1024 sc1
  buffer_load_dwordx4 v[72:75], v162, s[24:27], s28 offen offset:2048 sc1
  buffer_load_dwordx4 v[76:79], v162, s[24:27], s28 offen offset:3072 sc1
  ds_read_b32 v136, v145
  ds_read_b32 v10, v154 offset:56
  s_mov_b32 s20, s10
  s_and_b32 s21, s11, 0xffff
  s_mov_b32 s22, 2359296
  s_mov_b32 s23, 0x20000
  s_waitcnt lgkmcnt(0) vmcnt(4)
  v_readfirstlane_b32 s12, v10
  v_sub_f32 v137, 1.0, v136
  v_cvt_pk_bf16_f32 v137, v137, v137
  v_lshlrev_b32 v137, 16, v137
  v_lshlrev_b32 v146, 16, v128
  v_and_b32 v147, 0xffff0000, v128
  v_pk_mul_f32 v[146:147], v[146:147], v[136:137] op_sel:[0,1] op_sel_hi:[1,1]
  v_lshlrev_b32 v148, 16, v129
  v_and_b32 v149, 0xffff0000, v129
  v_pk_mul_f32 v[148:149], v[148:149], v[136:137] op_sel:[0,1] op_sel_hi:[1,1]
  v_lshlrev_b32 v150, 16, v130
  v_and_b32 v151, 0xffff0000, v130
  v_pk_mul_f32 v[150:151], v[150:151], v[136:137] op_sel:[0,1] op_sel_hi:[1,1]
  v_lshlrev_b32 v152, 16, v131
  v_and_b32 v153, 0xffff0000, v131
  v_pk_mul_f32 v[152:153], v[152:153], v[136:137] op_sel:[0,1] op_sel_hi:[1,1]
  s_waitcnt vmcnt(3) lgkmcnt(8)
L_oc0:
  v_cmp_eq_u32 vcc, -1, v64
  s_nop 1
  s_cbranch_vccnz L_or0
L_ok0:
  v_mfma_f32_16x16x32_bf16 v[52:55], v[20:23], v[64:67], 0
  buffer_load_dwordx4 v[80:83], v162, s[24:27], s96 offen offset:0 sc1
  ds_read_b64_tr_b16 v[100:101], v156 offset:8192
  ds_read_b64_tr_b16 v[102:103], v156 offset:10240
  v_mfma_f32_16x16x32_bf16 v[56:59], v[24:27], v[64:67], 0
  ds_read_b64_tr_b16 v[104:105], v157 offset:8192
  ds_read_b64_tr_b16 v[106:107], v157 offset:10240
  v_mfma_f32_16x16x32_bf16 v[60:63], v[28:31], v[64:67], 0
  ds_read_b64_tr_b16 v[108:109], v158 offset:8192
  ds_read_b64_tr_b16 v[110:111], v158 offset:10240
  v_mfma_f32_16x16x32_bf16 v[116:119], v[32:35], v[64:67], 0
  ds_read_b64_tr_b16 v[112:113], v159 offset:8192
  ds_read_b64_tr_b16 v[114:115], v159 offset:10240
  s_waitcnt vmcnt(3) lgkmcnt(8)
L_oc1:
  v_cmp_eq_u32 vcc, -1, v68
  s_nop 1
  s_cbranch_vccnz L_or1
L_ok1:
  v_mfma_f32_16x16x32_bf16 v[52:55], v[36:39], v[68:71], v[52:55]
  buffer_load_dwordx4 v[84:87], v162, s[24:27], s96 offen offset:1024 sc1
  ds_read_b64_tr_b16 v[20:21], v156 offset:12288
  ds_read_b64_tr_b16 v[22:23], v156 offset:14336
  v_mfma_f32_16x16x32_bf16 v[56:59], v[40:43], v[68:71], v[56:59]
  ds_read_b64_tr_b16 v[24:25], v157 offset:12288
  ds_read_b64_tr_b16 v[26:27], v157 offset:14336
  v_mfma_f32_16x16x32_bf16 v[60:63], v[44:47], v[68:71], v[60:63]
  ds_read_b64_tr_b16 v[28:29], v158 offset:12288
  ds_read_b64_tr_b16 v[30:31], v158 offset:14336
  v_mfma_f32_16x16x32_bf16 v[116:119], v[48:51], v[68:71], v[116:119]
  ds_read_b64_tr_b16 v[32:33], v159 offset:12288
  ds_read_b64_tr_b16 v[34:35], v159 offset:14336
  s_waitcnt vmcnt(3) lgkmcnt(8)
L_oc2:
  v_cmp_eq_u32 vcc, -1, v72
  s_nop 1
  s_cbranch_vccnz L_or2
L_ok2:
  v_mfma_f32_16x16x32_bf16 v[52:55], v[100:103], v[72:75], v[52:55]
  buffer_load_dwordx4 v[88:91], v162, s[24:27], s96 offen offset:2048 sc1
  ds_read_b64_tr_b16 v[36:37], v156 offset:16384
  ds_read_b64_tr_b16 v[38:39], v156 offset:18432
  v_mfma_f32_16x16x32_bf16 v[56:59], v[104:107], v[72:75], v[56:59]
  ds_read_b64_tr_b16 v[40:41], v157 offset:16384
  ds_read_b64_tr_b16 v[42:43], v157 offset:18432
  v_mfma_f32_16x16x32_bf16 v[60:63], v[108:111], v[72:75], v[60:63]
  ds_read_b64_tr_b16 v[44:45], v158 offset:16384
  ds_read_b64_tr_b16 v[46:47], v158 offset:18432
  v_mfma_f32_16x16x32_bf16 v[116:119], v[112:115], v[72:75], v[116:119]
  ds_read_b64_tr_b16 v[48:49], v159 offset:16384
  ds_read_b64_tr_b16 v[50:51], v159 offset:18432
  s_waitcnt vmcnt(3) lgkmcnt(8)
L_oc3:
  v_cmp_eq_u32 vcc, -1, v76
  s_nop 1
  s_cbranch_vccnz L_or3
L_ok3:
  v_mfma_f32_16x16x32_bf16 v[52:55], v[20:23], v[76:79], v[52:55]
  buffer_load_dwordx4 v[92:95], v162, s[24:27], s96 offen offset:3072 sc1
  ds_read_b64_tr_b16 v[100:101], v156 offset:20480
  ds_read_b64_tr_b16 v[102:103], v156 offset:22528
  v_mfma_f32_16x16x32_bf16 v[56:59], v[24:27], v[76:79], v[56:59]
  ds_read_b64_tr_b16 v[104:105], v157 offset:20480
  ds_read_b64_tr_b16 v[106:107], v157 offset:22528
  v_mfma_f32_16x16x32_bf16 v[60:63], v[28:31], v[76:79], v[60:63]
  ds_read_b64_tr_b16 v[108:109], v158 offset:20480
  ds_read_b64_tr_b16 v[110:111], v158 offset:22528
  v_mfma_f32_16x16x32_bf16 v[116:119], v[32:35], v[76:79], v[116:119]
  ds_read_b64_tr_b16 v[112:113], v159 offset:20480
  ds_read_b64_tr_b16 v[114:115], v159 offset:22528
  s_waitcnt vmcnt(3) lgkmcnt(8)
L_oc4:
  v_cmp_eq_u32 vcc, -1, v80
  s_nop 1
  s_cbranch_vccnz L_or4
L_ok4:
  v_mfma_f32_16x16x32_bf16 v[52:55], v[36:39], v[80:83], v[52:55]
  buffer_load_dwordx4 v[96:99], v162, s[24:27], s97 offen offset:0 sc1
  ds_read_b64_tr_b16 v[20:21], v156 offset:24576
  ds_read_b64_tr_b16 v[22:23], v156 offset:26624
  v_mfma_f32_16x16x32_bf16 v[56:59], v[40:43], v[80:83], v[56:59]
  ds_read_b64_tr_b16 v[24:25], v157 offset:24576
  ds_read_b64_tr_b16 v[26:27], v157 offset:26624
  v_mfma_f32_16x16x32_bf16 v[60:63], v[44:47], v[80:83], v[60:63]
  ds_read_b64_tr_b16 v[28:29], v158 offset:24576
  ds_read_b64_tr_b16 v[30:31], v158 offset:26624
  v_mfma_f32_16x16x32_bf16 v[116:119], v[48:51], v[80:83], v[116:119]
  ds_read_b64_tr_b16 v[32:33], v159 offset:24576
  ds_read_b64_tr_b16 v[34:35], v159 offset:26624
  s_waitcnt vmcnt(3) lgkmcnt(8)
L_oc5:
  v_cmp_eq_u32 vcc, -1, v84
  s_nop 1
  s_cbranch_vccnz L_or5
L_ok5:
  v_mfma_f32_16x16x32_bf16 v[52:55], v[100:103], v[84:87], v[52:55]
  ds_read_b64_tr_b16 v[36:37], v156 offset:28672
  ds_read_b64_tr_b16 v[38:39], v156 offset:30720
  v_mfma_f32_16x16x32_bf16 v[56:59], v[104:107], v[84:87], v[56:59]
  ds_read_b64_tr_b16 v[40:41], v157 offset:28672
  ds_read_b64_tr_b16 v[42:43], v157 offset:30720
  v_mfma_f32_16x16x32_bf16 v[60:63], v[108:111], v[84:87], v[60:63]
  ds_read_b64_tr_b16 v[44:45], v158 offset:28672
  ds_read_b64_tr_b16 v[46:47], v158 offset:30720
  v_mfma_f32_16x16x32_bf16 v[116:119], v[112:115], v[84:87], v[116:119]
  ds_read_b64_tr_b16 v[48:49], v159 offset:28672
  ds_read_b64_tr_b16 v[50:51], v159 offset:30720
  s_waitcnt vmcnt(2) lgkmcnt(8)
L_oc6:
  v_cmp_eq_u32 vcc, -1, v88
  s_nop 1
  s_cbranch_vccnz L_or6
L_ok6:
  v_mfma_f32_16x16x32_bf16 v[52:55], v[20:23], v[88:91], v[52:55]
  ds_read_b64_tr_b16 v[100:101], v156 offset:32768
  ds_read_b64_tr_b16 v[102:103], v156 offset:34816
  v_mfma_f32_16x16x32_bf16 v[56:59], v[24:27], v[88:91], v[56:59]
  ds_read_b64_tr_b16 v[104:105], v157 offset:32768
  ds_read_b64_tr_b16 v[106:107], v157 offset:34816
  v_mfma_f32_16x16x32_bf16 v[60:63], v[28:31], v[88:91], v[60:63]
  ds_read_b64_tr_b16 v[108:109], v158 offset:32768
  ds_read_b64_tr_b16 v[110:111], v158 offset:34816
  v_mfma_f32_16x16x32_bf16 v[116:119], v[32:35], v[88:91], v[116:119]
  ds_read_b64_tr_b16 v[112:113], v159 offset:32768
  ds_read_b64_tr_b16 v[114:115], v159 offset:34816
  s_waitcnt vmcnt(1) lgkmcnt(8)
L_oc7:
  v_max3_u32 v10, v92, v93, v94
  v_max_u32 v10, v10, v95
  v_cmp_eq_u32 vcc, -1, v10
  s_nop 1
  s_cbranch_vccnz L_or7
L_ok7:
  v_mfma_f32_16x16x32_bf16 v[52:55], v[36:39], v[92:95], v[52:55]
  v_mfma_f32_16x16x32_bf16 v[56:59], v[40:43], v[92:95], v[56:59]
  v_mfma_f32_16x16x32_bf16 v[60:63], v[44:47], v[92:95], v[60:63]
  v_mfma_f32_16x16x32_bf16 v[116:119], v[48:51], v[92:95], v[116:119]
  s_waitcnt vmcnt(0) lgkmcnt(0)
L_oc8:
  v_max3_u32 v10, v96, v97, v98
  v_max_u32 v10, v10, v99
  v_cmp_eq_u32 vcc, -1, v10
  s_nop 1
  s_cbranch_vccnz L_or8
L_ok8:
  v_mfma_f32_16x16x32_bf16 v[52:55], v[100:103], v[96:99], v[52:55]
  v_mfma_f32_16x16x32_bf16 v[56:59], v[104:107], v[96:99], v[56:59]
  v_mfma_f32_16x16x32_bf16 v[60:63], v[108:111], v[96:99], v[60:63]
  v_mfma_f32_16x16x32_bf16 v[116:119], v[112:115], v[96:99], v[116:119]
  v_mov_b32 v10, 1
  s_nop 5
  ds_write_b128 v164, v[60:63]
  ds_write_b128 v164, v[116:119] offset:1024
  ds_write_b32 v165, v10 offset:88
  s_lshr_b32 s46, s12, 4
  s_cmp_eq_u32 s46, s13
  s_cbranch_scc0 L_noy
  s_mov_b32 s60, 0x200000
L_yw:
  ds_read_b32 v10, v154 offset:32
  s_waitcnt lgkmcnt(0)
  v_readfirstlane_b32 s61, v10
  s_nop 0
  s_cmp_eq_u32 s61, 1
  s_cbranch_scc1 L_yw_d
  s_sleep 1
  s_sub_u32 s60, s60, 1
  s_cmp_lg_u32 s60, 0
  s_cbranch_scc1 L_yw
L_yw_d:
  s_lshl_b32 s46, s6, 7
  s_add_u32 s46, s46, 149696
  v_lshl_add_u32 v10, v141, 5, s46
  ds_read_b128 v[12:15], v10
  ds_read_b128 v[16:19], v10 offset:16
  s_and_b32 s46, s12, 15
  v_cmp_eq_u32 s[50:51], s46, v140
  s_waitcnt lgkmcnt(0)
  v_lshlrev_b32 v10, 16, v128
  v_and_b32 v11, 0xffff0000, v128
  v_add_f32 v10, v10, v12
  v_add_f32 v11, v11, v13
  v_cvt_pk_bf16_f32 v10, v10, v11
  v_cndmask_b32 v128, v128, v10, s[50:51]
  v_lshlrev_b32 v10, 16, v129
  v_and_b32 v11, 0xffff0000, v129
  v_add_f32 v10, v10, v14
  v_add_f32 v11, v11, v15
  v_cvt_pk_bf16_f32 v10, v10, v11
  v_cndmask_b32 v129, v129, v10, s[50:51]
  v_lshlrev_b32 v10, 16, v130
  v_and_b32 v11, 0xffff0000, v130
  v_add_f32 v10, v10, v16
  v_add_f32 v11, v11, v17
  v_cvt_pk_bf16_f32 v10, v10, v11
  v_cndmask_b32 v130, v130, v10, s[50:51]
  v_lshlrev_b32 v10, 16, v131
  v_and_b32 v11, 0xffff0000, v131
  v_add_f32 v10, v10, v18
  v_add_f32 v11, v11, v19
  v_cvt_pk_bf16_f32 v10, v10, v11
  v_cndmask_b32 v131, v131, v10, s[50:51]
  v_lshlrev_b32 v146, 16, v128
  v_and_b32 v147, 0xffff0000, v128
  v_pk_mul_f32 v[146:147], v[146:147], v[136:137] op_sel:[0,1] op_sel_hi:[1,1]
  v_lshlrev_b32 v148, 16, v129
  v_and_b32 v149, 0xffff0000, v129
  v_pk_mul_f32 v[148:149], v[148:149], v[136:137] op_sel:[0,1] op_sel_hi:[1,1]
  v_lshlrev_b32 v150, 16, v130
  v_and_b32 v151, 0xffff0000, v130
  v_pk_mul_f32 v[150:151], v[150:151], v[136:137] op_sel:[0,1] op_sel_hi:[1,1]
  v_lshlrev_b32 v152, 16, v131
  v_and_b32 v153, 0xffff0000, v131
  v_pk_mul_f32 v[152:153], v[152:153], v[136:137] op_sel:[0,1] op_sel_hi:[1,1]
L_noy:
  s_mov_b32 s60, 0x200000
L_pw:
  ds_read_b32 v10, v161 offset:88
  s_waitcnt lgkmcnt(0)
  v_readfirstlane_b32 s61, v10
  s_nop 0
  s_cmp_eq_u32 s61, 1
  s_cbranch_scc1 L_pw_d
  s_sub_u32 s60, s60, 1
  s_cmp_lg_u32 s60, 0
  s_cbranch_scc1 L_pw
L_pw_d:
  ds_read_b128 v[20:23], v160 offset:0
  ds_read_b128 v[24:27], v160 offset:1024
  s_waitcnt lgkmcnt(0)
  v_pk_add_f32 v[52:53], v[52:53], v[20:21]
  v_pk_add_f32 v[54:55], v[54:55], v[22:23]
  v_cvt_pk_bf16_f32 v40, v52, v53
  v_cvt_pk_bf16_f32 v41, v54, v55
  ds_write_b64 v143, v[40:41] offset:0
  v_pk_add_f32 v[56:57], v[56:57], v[24:25]
  v_pk_add_f32 v[58:59], v[58:59], v[26:27]
  v_cvt_pk_bf16_f32 v42, v56, v57
  v_cvt_pk_bf16_f32 v43, v58, v59
  ds_write_b64 v143, v[42:43] offset:32
  ds_read_b128 v[20:23], v144
  s_waitcnt lgkmcnt(0)
  v_lshlrev_b32 v10, 16, v20
  v_and_b32 v11, 0xffff0000, v20
  v_pk_fma_f32 v[146:147], v[10:11], v[136:137], v[146:147] op_sel_hi:[1,0,1]
  v_lshlrev_b32 v12, 16, v21
  v_and_b32 v13, 0xffff0000, v21
  v_pk_fma_f32 v[148:149], v[12:13], v[136:137], v[148:149] op_sel_hi:[1,0,1]
  v_lshlrev_b32 v14, 16, v22
  v_and_b32 v15, 0xffff0000, v22
  v_pk_fma_f32 v[150:151], v[14:15], v[136:137], v[150:151] op_sel_hi:[1,0,1]
  v_lshlrev_b32 v16, 16, v23
  v_and_b32 v17, 0xffff0000, v23
  v_pk_fma_f32 v[152:153], v[16:17], v[136:137], v[152:153] op_sel_hi:[1,0,1]
  v_cvt_pk_bf16_f32 v32, v146, v147
  v_cvt_pk_bf16_f32 v33, v148, v149
  v_cvt_pk_bf16_f32 v34, v150, v151
  v_cvt_pk_bf16_f32 v35, v152, v153
  buffer_store_dwordx4 v[32:35], v142, s[20:23], s29 offen
  s_endpgm
L_or0:
  s_sub_u32 s60, s60, 1
  s_cbranch_scc1 L_ok0
  s_waitcnt vmcnt(0)
  buffer_load_dwordx4 v[64:67], v162, s[24:27], s28 offen offset:0 sc1
  buffer_load_dwordx4 v[68:71], v162, s[24:27], s28 offen offset:1024 sc1
  buffer_load_dwordx4 v[72:75], v162, s[24:27], s28 offen offset:2048 sc1
  buffer_load_dwordx4 v[76:79], v162, s[24:27], s28 offen offset:3072 sc1
  s_waitcnt vmcnt(3)
  s_branch L_oc0
L_or1:
  s_sub_u32 s60, s60, 1
  s_cbranch_scc1 L_ok1
  s_waitcnt vmcnt(0)
  buffer_load_dwordx4 v[68:71], v162, s[24:27], s28 offen offset:1024 sc1
  buffer_load_dwordx4 v[72:75], v162, s[24:27], s28 offen offset:2048 sc1
  buffer_load_dwordx4 v[76:79], v162, s[24:27], s28 offen offset:3072 sc1
  buffer_load_dwordx4 v[80:83], v162, s[24:27], s96 offen offset:0 sc1
  s_waitcnt vmcnt(3)
  s_branch L_oc1
L_or2:
  s_sub_u32 s60, s60, 1
  s_cbranch_scc1 L_ok2
  s_waitcnt vmcnt(0)
  buffer_load_dwordx4 v[72:75], v162, s[24:27], s28 offen offset:2048 sc1
  buffer_load_dwordx4 v[76:79], v162, s[24:27], s28 offen offset:3072 sc1
  buffer_load_dwordx4 v[80:83], v162, s[24:27], s96 offen offset:0 sc1
  buffer_load_dwordx4 v[84:87], v162, s[24:27], s96 offen offset:1024 sc1
  s_waitcnt vmcnt(3)
  s_branch L_oc2
L_or3:
  s_sub_u32 s60, s60, 1
  s_cbranch_scc1 L_ok3
  s_waitcnt vmcnt(0)
  buffer_load_dwordx4 v[76:79], v162, s[24:27], s28 offen offset:3072 sc1
  buffer_load_dwordx4 v[80:83], v162, s[24:27], s96 offen offset:0 sc1
  buffer_load_dwordx4 v[84:87], v162, s[24:27], s96 offen offset:1024 sc1
  buffer_load_dwordx4 v[88:91], v162, s[24:27], s96 offen offset:2048 sc1
  s_waitcnt vmcnt(3)
  s_branch L_oc3
L_or4:
  s_sub_u32 s60, s60, 1
  s_cbranch_scc1 L_ok4
  s_waitcnt vmcnt(0)
  buffer_load_dwordx4 v[80:83], v162, s[24:27], s96 offen offset:0 sc1
  buffer_load_dwordx4 v[84:87], v162, s[24:27], s96 offen offset:1024 sc1
  buffer_load_dwordx4 v[88:91], v162, s[24:27], s96 offen offset:2048 sc1
  buffer_load_dwordx4 v[92:95], v162, s[24:27], s96 offen offset:3072 sc1
  s_waitcnt vmcnt(3)
  s_branch L_oc4
L_or5:
  s_sub_u32 s60, s60, 1
  s_cbranch_scc1 L_ok5
  s_waitcnt vmcnt(0)
  buffer_load_dwordx4 v[84:87], v162, s[24:27], s96 offen offset:1024 sc1
  buffer_load_dwordx4 v[88:91], v162, s[24:27], s96 offen offset:2048 sc1
  buffer_load_dwordx4 v[92:95], v162, s[24:27], s96 offen offset:3072 sc1
  buffer_load_dwordx4 v[96:99], v162, s[24:27], s97 offen offset:0 sc1
  s_waitcnt vmcnt(3)
  s_branch L_oc5
L_or6:
  s_sub_u32 s60, s60, 1
  s_cbranch_scc1 L_ok6
  s_waitcnt vmcnt(0)
  buffer_load_dwordx4 v[88:91], v162, s[24:27], s96 offen offset:2048 sc1
  buffer_load_dwordx4 v[92:95], v162, s[24:27], s96 offen offset:3072 sc1
  buffer_load_dwordx4 v[96:99], v162, s[24:27], s97 offen offset:0 sc1
  s_waitcnt vmcnt(2)
  s_branch L_oc6
L_or7:
  s_sub_u32 s60, s60, 1
  s_cbranch_scc1 L_ok7
  s_waitcnt vmcnt(0)
  buffer_load_dwordx4 v[92:95], v162, s[24:27], s96 offen offset:3072 sc1
  buffer_load_dwordx4 v[96:99], v162, s[24:27], s97 offen offset:0 sc1
  s_waitcnt vmcnt(1)
  s_branch L_oc7
L_or8:
  s_sub_u32 s60, s60, 1
  s_cbranch_scc1 L_ok8
  s_waitcnt vmcnt(0)
  buffer_load_dwordx4 v[96:99], v162, s[24:27], s97 offen offset:0 sc1
  s_waitcnt vmcnt(0)
  s_branch L_oc8
L_late:
  s_mul_i32 s50, s41, 2304
  v_add_u32 v120, s50, v1
  v_add_u32 v121, s50, v2
  v_mul_u32_u24 v114, s41, v4
  v_add_u32 v3, v3, v114
  v_mov_b32 v96, 0
  v_mov_b32 v97, 0
  v_mov_b32 v98, 0
  v_mov_b32 v99, 0
  v_mov_b32 v100, 0
  v_mov_b32 v101, 0
  v_mov_b32 v102, 0
  v_mov_b32 v103, 0
  v_mov_b32 v104, 0
  v_mov_b32 v105, 0
  v_mov_b32 v106, 0
  v_mov_b32 v107, 0
  v_mov_b32 v108, 0
  v_mov_b32 v109, 0
  v_mov_b32 v110, 0
  v_mov_b32 v111, 0
  v_mov_b32 v32, 0
  v_mov_b32 v33, 0
  v_mov_b32 v34, 0
  v_mov_b32 v35, 0
  v_mov_b32 v36, 0
  v_mov_b32 v37, 0
  v_mov_b32 v38, 0
  v_mov_b32 v39, 0
  v_mov_b32 v40, 0
  v_mov_b32 v41, 0
  v_mov_b32 v42, 0
  v_mov_b32 v43, 0
  v_mov_b32 v44, 0
  v_mov_b32 v45, 0
  v_mov_b32 v46, 0
  v_mov_b32 v47, 0
  v_mov_b32 v48, 0
  v_mov_b32 v49, 0
  v_mov_b32 v50, 0
  v_mov_b32 v51, 0
  v_mov_b32 v52, 0
  v_mov_b32 v53, 0
  v_mov_b32 v54, 0
  v_mov_b32 v55, 0
  v_mov_b32 v56, 0
  v_mov_b32 v57, 0
  v_mov_b32 v58, 0
  v_mov_b32 v59, 0
  v_mov_b32 v60, 0
  v_mov_b32 v61, 0
  v_mov_b32 v62, 0
  v_mov_b32 v63, 0
  v_mov_b32 v112, 0x1
  s_waitcnt vmcnt(0)
  s_mov_b64 exec, 1
  ds_add_u32 v154, v112 offset:8
  s_mov_b64 exec, -1
  s_mov_b32 s60, 0x200000
L_lt:
  ds_read_b32 v112, v154 offset:8
  s_waitcnt lgkmcnt(0)
  v_readfirstlane_b32 s61, v112
  s_nop 0
  s_bitcmp1_b32 s61, 3
  s_cbranch_scc1 L_lt_d
  s_sub_u32 s60, s60, 1
  s_cmp_lg_u32 s60, 0
  s_cbranch_scc1 L_lt
L_lt_d:
  ds_read_b64 v[6:7], v1 offset:55296
  ds_read_b64 v[8:9], v1 offset:55304
  ds_read_b64 v[10:11], v2 offset:55296
  s_waitcnt lgkmcnt(0)
  v_mov_b32 v112, 1
  s_mov_b64 exec, 1
  ds_add_u32 v154, v112 offset:36
  s_mov_b64 exec, -1
  s_mov_b32 s20, s4
  s_and_b32 s21, s5, 0xffff
  s_mov_b32 s22, 2359296
  s_mov_b32 s23, 0x20000
  buffer_load_dwordx4 v[128:131], v142, s[20:23], s29 offen
  s_bitcmp1_b32 s41, 0
  s_cbranch_scc1 L_late1
  ds_read_b64 v[20:21], v120 offset:0
  ds_read_b64 v[22:23], v120 offset:8
  ds_read_b64 v[24:25], v121 offset:0
  ds_read_b64 v[26:27], v120 offset:2304
  ds_read_b64 v[28:29], v120 offset:2312
  ds_read_b64 v[30:31], v121 offset:2304
  ds_read_b64_tr_b16 v[32:33], v3 offset:0
  ds_read_b64_tr_b16 v[34:35], v3 offset:576
  ds_read_b64_tr_b16 v[36:37], v3 offset:1152
  ds_read_b64_tr_b16 v[38:39], v3 offset:1728
  s_waitcnt lgkmcnt(7)
  v_cndmask_b32 v10, 0, v10, s[54:55]
  v_cndmask_b32 v11, 0, v11, s[56:57]
  v_mfma_f32_32x32x16_bf16 v[64:79], v[20:23], v[6:9], 0
  s_nop 0
  v_mfma_f32_32x32x8_bf16 v[64:79], v[24:25], v[10:11], v[64:79]
  s_nop 7
  s_nop 3
  s_cmp_eq_u32 s41, 2
  s_cbranch_scc1 L_it2
  s_cmp_eq_u32 s41, 4
  s_cbranch_scc1 L_it4
  s_cmp_eq_u32 s41, 6
  s_cbranch_scc1 L_it6
  s_cmp_eq_u32 s41, 8
  s_cbranch_scc1 L_it8
  s_branch L_it8
L_late1:
  ds_read_b64 v[26:27], v120 offset:0
  ds_read_b64 v[28:29], v120 offset:8
  ds_read_b64 v[30:31], v121 offset:0
  ds_read_b64 v[20:21], v120 offset:2304
  ds_read_b64 v[22:23], v120 offset:2312
  ds_read_b64 v[24:25], v121 offset:2304
  ds_read_b64_tr_b16 v[40:41], v3 offset:0
  ds_read_b64_tr_b16 v[42:43], v3 offset:576
  ds_read_b64_tr_b16 v[44:45], v3 offset:1152
  ds_read_b64_tr_b16 v[46:47], v3 offset:1728
  s_waitcnt lgkmcnt(7)
  v_cndmask_b32 v10, 0, v10, s[54:55]
  v_cndmask_b32 v11, 0, v11, s[56:57]
  v_mfma_f32_32x32x16_bf16 v[80:95], v[26:29], v[6:9], 0
  s_nop 0
  v_mfma_f32_32x32x8_bf16 v[80:95], v[30:31], v[10:11], v[80:95]
  s_nop 7
  s_nop 3
  s_cmp_eq_u32 s41, 1
  s_cbranch_scc1 L_it1
  s_cmp_eq_u32 s41, 3
  s_cbranch_scc1 L_it3
  s_cmp_eq_u32 s41, 5
  s_cbranch_scc1 L_it5
  s_cmp_eq_u32 s41, 7
  s_cbranch_scc1 L_it7
  s_branch L_it7
L_slow:
  v_and_b32 v112, 31, v0
  v_lshrrev_b32 v113, 5, v0
  v_lshlrev_b32 v123, 2, v113
  v_sub_u32 v123, v123, v112
  v_mov_b32 v124, 0xff800000
  v_mov_b32 v122, v124
  s_max_i32 s50, s41, 0
  s_sub_u32 s51, 8, s50
  v_mul_u32_u24 v112, s51, v4
  v_sub_u32 v3, v3, v112
  s_mul_i32 s51, s50, 2304
  v_mov_b32 v96, 0
  v_mov_b32 v97, 0
  v_mov_b32 v98, 0
  v_mov_b32 v99, 0
  v_mov_b32 v100, 0
  v_mov_b32 v101, 0
  v_mov_b32 v102, 0
  v_mov_b32 v103, 0
  v_mov_b32 v104, 0
  v_mov_b32 v105, 0
  v_mov_b32 v106, 0
  v_mov_b32 v107, 0
  v_mov_b32 v108, 0
  v_mov_b32 v109, 0
  v_mov_b32 v110, 0
  v_mov_b32 v111, 0
  v_add_u32 v120, s51, v1
  v_add_u32 v121, s51, v2
  s_mov_b32 s46, s50
L_sp0:
  ds_read_b64 v[20:21], v120 offset:0
  ds_read_b64 v[22:23], v120 offset:8
  ds_read_b64 v[24:25], v121 offset:0
  s_mov_b32 s47, -31
  s_mov_b32 s48, 62
  s_cmp_eq_u32 s46, 0
  s_cselect_b32 s47, 1, s47
  s_cselect_b32 s48, 30, s48
  s_cmp_eq_u32 s46, 8
  s_cselect_b32 s48, 31, s48
  s_waitcnt lgkmcnt(0)
  v_mfma_f32_32x32x16_bf16 v[64:79], v[20:23], v[6:9], 0
  v_mfma_f32_32x32x8_bf16 v[64:79], v[24:25], v[10:11], v[64:79]
  v_subrev_u32 v112, s47, v123
  v_add_u32 v113, 0, v112
  v_cmp_ge_u32 vcc, s48, v113
  s_nop 8
  v_cndmask_b32 v64, v124, v64, vcc
  v_max_f32 v122, v122, v64
  v_add_u32 v113, 1, v112
  v_cmp_ge_u32 vcc, s48, v113
  s_nop 1
  v_cndmask_b32 v65, v124, v65, vcc
  v_max_f32 v122, v122, v65
  v_add_u32 v113, 2, v112
  v_cmp_ge_u32 vcc, s48, v113
  s_nop 1
  v_cndmask_b32 v66, v124, v66, vcc
  v_max_f32 v122, v122, v66
  v_add_u32 v113, 3, v112
  v_cmp_ge_u32 vcc, s48, v113
  s_nop 1
  v_cndmask_b32 v67, v124, v67, vcc
  v_max_f32 v122, v122, v67
  v_add_u32 v113, 8, v112
  v_cmp_ge_u32 vcc, s48, v113
  s_nop 1
  v_cndmask_b32 v68, v124, v68, vcc
  v_max_f32 v122, v122, v68
  v_add_u32 v113, 9, v112
  v_cmp_ge_u32 vcc, s48, v113
  s_nop 1
  v_cndmask_b32 v69, v124, v69, vcc
  v_max_f32 v122, v122, v69
  v_add_u32 v113, 10, v112
  v_cmp_ge_u32 vcc, s48, v113
  s_nop 1
  v_cndmask_b32 v70, v124, v70, vcc
  v_max_f32 v122, v122, v70
  v_add_u32 v113, 11, v112
  v_cmp_ge_u32 vcc, s48, v113
  s_nop 1
  v_cndmask_b32 v71, v124, v71, vcc
  v_max_f32 v122, v122, v71
  v_add_u32 v113, 16, v112
  v_cmp_ge_u32 vcc, s48, v113
  s_nop 1
  v_cndmask_b32 v72, v124, v72, vcc
  v_max_f32 v122, v122, v72
  v_add_u32 v113, 17, v112
  v_cmp_ge_u32 vcc, s48, v113
  s_nop 1
  v_cndmask_b32 v73, v124, v73, vcc
  v_max_f32 v122, v122, v73
  v_add_u32 v113, 18, v112
  v_cmp_ge_u32 vcc, s48, v113
  s_nop 1
  v_cndmask_b32 v74, v124, v74, vcc
  v_max_f32 v122, v122, v74
  v_add_u32 v113, 19, v112
  v_cmp_ge_u32 vcc, s48, v113
  s_nop 1
  v_cndmask_b32 v75, v124, v75, vcc
  v_max_f32 v122, v122, v75
  v_add_u32 v113, 24, v112
  v_cmp_ge_u32 vcc, s48, v113
  s_nop 1
  v_cndmask_b32 v76, v124, v76, vcc
  v_max_f32 v122, v122, v76
  v_add_u32 v113, 25, v112
  v_cmp_ge_u32 vcc, s48, v113
  s_nop 1
  v_cndmask_b32 v77, v124, v77, vcc
  v_max_f32 v122, v122, v77
  v_add_u32 v113, 26, v112
  v_cmp_ge_u32 vcc, s48, v113
  s_nop 1
  v_cndmask_b32 v78, v124, v78, vcc
  v_max_f32 v122, v122, v78
  v_add_u32 v113, 27, v112
  v_cmp_ge_u32 vcc, s48, v113
  s_nop 1
  v_cndmask_b32 v79, v124, v79, vcc
  v_max_f32 v122, v122, v79
  v_add_u32 v120, 2304, v120
  v_add_u32 v121, 2304, v121
  s_add_u32 s46, s46, 1
  s_cmp_lt_u32 s46, 9
  s_nop 7
  s_nop 7
  s_cbranch_scc1 L_sp0
  v_mov_b32 v112, v122
  s_nop 1
  v_permlane32_swap_b32 v112, v122
  v_max_f32 v122, v122, v112
  v_add_u32 v120, s51, v1
  v_add_u32 v121, s51, v2
  s_mov_b32 s46, s50
L_sp1:
  ds_read_b64 v[20:21], v120 offset:0
  ds_read_b64 v[22:23], v120 offset:8
  ds_read_b64 v[24:25], v121 offset:0
  ds_read_b64_tr_b16 v[32:33], v3 offset:0
  ds_read_b64_tr_b16 v[34:35], v3 offset:576
  ds_read_b64_tr_b16 v[36:37], v3 offset:1152
  ds_read_b64_tr_b16 v[38:39], v3 offset:1728
  s_mov_b32 s47, -31
  s_mov_b32 s48, 62
  s_cmp_eq_u32 s46, 0
  s_cselect_b32 s47, 1, s47
  s_cselect_b32 s48, 30, s48
  s_cmp_eq_u32 s46, 8
  s_cselect_b32 s48, 31, s48
  s_waitcnt lgkmcnt(0)
  v_mfma_f32_32x32x16_bf16 v[64:79], v[20:23], v[6:9], 0
  v_mfma_f32_32x32x8_bf16 v[64:79], v[24:25], v[10:11], v[64:79]
  v_subrev_u32 v112, s47, v123
  v_add_u32 v113, 0, v112
  v_cmp_ge_u32 vcc, s48, v113
  s_nop 8
  v_cndmask_b32 v64, v124, v64, vcc
  v_sub_f32 v64, v64, v122
  v_exp_f32 v64, v64
  v_add_u32 v113, 1, v112
  v_cmp_ge_u32 vcc, s48, v113
  s_nop 1
  v_cndmask_b32 v65, v124, v65, vcc
  v_sub_f32 v65, v65, v122
  v_exp_f32 v65, v65
  v_add_u32 v113, 2, v112
  v_cmp_ge_u32 vcc, s48, v113
  s_nop 1
  v_cndmask_b32 v66, v124, v66, vcc
  v_sub_f32 v66, v66, v122
  v_exp_f32 v66, v66
  v_add_u32 v113, 3, v112
  v_cmp_ge_u32 vcc, s48, v113
  s_nop 1
  v_cndmask_b32 v67, v124, v67, vcc
  v_sub_f32 v67, v67, v122
  v_exp_f32 v67, v67
  v_add_u32 v113, 8, v112
  v_cmp_ge_u32 vcc, s48, v113
  s_nop 1
  v_cndmask_b32 v68, v124, v68, vcc
  v_sub_f32 v68, v68, v122
  v_exp_f32 v68, v68
  v_add_u32 v113, 9, v112
  v_cmp_ge_u32 vcc, s48, v113
  s_nop 1
  v_cndmask_b32 v69, v124, v69, vcc
  v_sub_f32 v69, v69, v122
  v_exp_f32 v69, v69
  v_add_u32 v113, 10, v112
  v_cmp_ge_u32 vcc, s48, v113
  s_nop 1
  v_cndmask_b32 v70, v124, v70, vcc
  v_sub_f32 v70, v70, v122
  v_exp_f32 v70, v70
  v_add_u32 v113, 11, v112
  v_cmp_ge_u32 vcc, s48, v113
  s_nop 1
  v_cndmask_b32 v71, v124, v71, vcc
  v_sub_f32 v71, v71, v122
  v_exp_f32 v71, v71
  v_add_u32 v113, 16, v112
  v_cmp_ge_u32 vcc, s48, v113
  s_nop 1
  v_cndmask_b32 v72, v124, v72, vcc
  v_sub_f32 v72, v72, v122
  v_exp_f32 v72, v72
  v_add_u32 v113, 17, v112
  v_cmp_ge_u32 vcc, s48, v113
  s_nop 1
  v_cndmask_b32 v73, v124, v73, vcc
  v_sub_f32 v73, v73, v122
  v_exp_f32 v73, v73
  v_add_u32 v113, 18, v112
  v_cmp_ge_u32 vcc, s48, v113
  s_nop 1
  v_cndmask_b32 v74, v124, v74, vcc
  v_sub_f32 v74, v74, v122
  v_exp_f32 v74, v74
  v_add_u32 v113, 19, v112
  v_cmp_ge_u32 vcc, s48, v113
  s_nop 1
  v_cndmask_b32 v75, v124, v75, vcc
  v_sub_f32 v75, v75, v122
  v_exp_f32 v75, v75
  v_add_u32 v113, 24, v112
  v_cmp_ge_u32 vcc, s48, v113
  s_nop 1
  v_cndmask_b32 v76, v124, v76, vcc
  v_sub_f32 v76, v76, v122
  v_exp_f32 v76, v76
  v_add_u32 v113, 25, v112
  v_cmp_ge_u32 vcc, s48, v113
  s_nop 1
  v_cndmask_b32 v77, v124, v77, vcc
  v_sub_f32 v77, v77, v122
  v_exp_f32 v77, v77
  v_add_u32 v113, 26, v112
  v_cmp_ge_u32 vcc, s48, v113
  s_nop 1
  v_cndmask_b32 v78, v124, v78, vcc
  v_sub_f32 v78, v78, v122
  v_exp_f32 v78, v78
  v_add_u32 v113, 27, v112
  v_cmp_ge_u32 vcc, s48, v113
  s_nop 1
  v_cndmask_b32 v79, v124, v79, vcc
  v_sub_f32 v79, v79, v122
  v_exp_f32 v79, v79
  v_cvt_pk_bf16_f32 v48, v64, v65
  v_cvt_pk_bf16_f32 v49, v66, v67
  v_cvt_pk_bf16_f32 v50, v68, v69
  v_cvt_pk_bf16_f32 v51, v70, v71
  v_cvt_pk_bf16_f32 v52, v72, v73
  v_cvt_pk_bf16_f32 v53, v74, v75
  v_cvt_pk_bf16_f32 v54, v76, v77
  v_cvt_pk_bf16_f32 v55, v78, v79
  v_mfma_f32_32x32x16_bf16 v[96:111], v[32:35], v[48:51], v[96:111]
  s_nop 0
  v_mfma_f32_32x32x16_bf16 v[96:111], v[36:39], v[52:55], v[96:111]
  v_add_u32 v3, v3, v4
  v_add_u32 v120, 2304, v120
  v_add_u32 v121, 2304, v121
  s_add_u32 s46, s46, 1
  s_cmp_lt_u32 s46, 9
  s_nop 7
  s_nop 7
  s_cbranch_scc1 L_sp1
  v_rcp_f32 v112, v108
  s_nop 1
  s_branch L_fin
L_sp:
  s_sub_u32 s36, s2, 192
  s_cmp_ge_u32 s3, 8
  s_cbranch_scc1 L_sp_ffn
  s_cmp_ge_u32 s3, 4
  s_cbranch_scc1 L_sp_hi
  s_load_dwordx2 s[60:61], s[0:1], 32
  s_load_dwordx2 s[62:63], s[0:1], 64
  v_lshrrev_b32 v2, 3, v0
  v_and_b32 v3, 7, v0
  v_lshlrev_b32 v3, 4, v3
  s_lshl_b32 s34, s36, 2
  s_add_u32 s34, s34, s3
  s_lshl_b32 s33, s34, 3
  v_add_u32 v1, s33, v2
  v_mul_u32_u24 v4, 1152, v1
  v_add_u32 v4, v4, v3
  s_mul_i32 s51, s34, 896
  s_mul_i32 s52, s34, 2688
  v_lshlrev_b32 v7, 7, v0
  s_waitcnt lgkmcnt(0)
  s_mov_b32 s64, 10371072
  s_load_dword s65, s[8:9], s64
  s_mov_b32 s16, s6
  s_and_b32 s17, s7, 0xffff
  s_mov_b32 s18, 1990656
  s_mov_b32 s19, 0x20000
  s_mov_b32 s20, s28
  s_and_b32 s21, s29, 0xffff
  s_mov_b32 s22, 663552
  s_mov_b32 s23, 0x20000
  global_load_dwordx4 v[16:19], v4, s[4:5] offset:256
  global_load_dwordx4 v[44:47], v3, s[60:61] offset:0
  global_load_dwordx4 v[80:83], v3, s[62:63] offset:0
  global_load_dwordx4 v[48:51], v3, s[60:61] offset:128
  global_load_dwordx4 v[84:87], v3, s[62:63] offset:128
  global_load_dwordx4 v[52:55], v3, s[60:61] offset:256
  global_load_dwordx4 v[88:91], v3, s[62:63] offset:256
  global_load_dwordx4 v[56:59], v3, s[60:61] offset:384
  global_load_dwordx4 v[92:95], v3, s[62:63] offset:384
  global_load_dwordx4 v[60:63], v3, s[60:61] offset:512
  global_load_dwordx4 v[96:99], v3, s[62:63] offset:512
  global_load_dwordx4 v[64:67], v3, s[60:61] offset:640
  global_load_dwordx4 v[100:103], v3, s[62:63] offset:640
  global_load_dwordx4 v[68:71], v3, s[60:61] offset:768
  global_load_dwordx4 v[104:107], v3, s[62:63] offset:768
  global_load_dwordx4 v[72:75], v3, s[60:61] offset:896
  global_load_dwordx4 v[108:111], v3, s[62:63] offset:896
  global_load_dwordx4 v[76:79], v3, s[60:61] offset:1024
  global_load_dwordx4 v[112:115], v3, s[62:63] offset:1024
  s_add_u32 s53, s51, 442368
  s_mov_b64 exec, 0x7f
  buffer_load_dword v124, v7, s[16:19], s53 offen
  s_mov_b64 exec, -1
  global_load_dwordx4 v[20:23], v4, s[4:5] offset:384
  s_add_u32 s53, s51, 663552
  s_mov_b64 exec, 0x7f
  buffer_load_dword v124, v7, s[16:19], s53 offen
  s_mov_b64 exec, -1
  global_load_dwordx4 v[24:27], v4, s[4:5] offset:512
  s_add_u32 s53, s51, 884736
  s_mov_b64 exec, 0x7f
  buffer_load_dword v124, v7, s[16:19], s53 offen
  s_mov_b64 exec, -1
  global_load_dwordx4 v[28:31], v4, s[4:5] offset:640
  s_add_u32 s53, s51, 1105920
  s_mov_b64 exec, 0x7f
  buffer_load_dword v124, v7, s[16:19], s53 offen
  s_mov_b64 exec, -1
  global_load_dwordx4 v[32:35], v4, s[4:5] offset:768
  s_add_u32 s53, s51, 1327104
  s_mov_b64 exec, 0x7f
  buffer_load_dword v124, v7, s[16:19], s53 offen
  s_mov_b64 exec, -1
  global_load_dwordx4 v[36:39], v4, s[4:5] offset:896
  s_add_u32 s53, s51, 1548288
  s_mov_b64 exec, 0x7f
  buffer_load_dword v124, v7, s[16:19], s53 offen
  s_mov_b64 exec, -1
  global_load_dwordx4 v[40:43], v4, s[4:5] offset:1024
  s_add_u32 s53, s51, 1769472
  s_mov_b64 exec, 0x7f
  buffer_load_dword v124, v7, s[16:19], s53 offen
  s_mov_b64 exec, -1
  global_load_dwordx4 v[8:11], v4, s[4:5] offset:0
  global_load_dwordx4 v[12:15], v4, s[4:5] offset:128
  s_mov_b64 exec, 0x1fffff
  buffer_load_dword v124, v7, s[20:23], s52 offen
  s_mov_b64 exec, -1
  v_mov_b32 v154, 149568
  s_waitcnt lgkmcnt(0)
  s_mul_i32 s65, s65, 0x9e3779b1
  s_add_u32 s65, s65, 0x7f4a7c15
  s_barrier
  s_waitcnt vmcnt(1)
  v_dot2_f32_bf16 v116, v8, v44, 0
  v_dot2_f32_bf16 v117, v9, v45, 0
  v_dot2_f32_bf16 v118, v10, v46, 0
  v_dot2_f32_bf16 v119, v11, v47, 0
  v_dot2_f32_bf16 v116, v12, v48, v116
  v_dot2_f32_bf16 v117, v13, v49, v117
  v_dot2_f32_bf16 v118, v14, v50, v118
  v_dot2_f32_bf16 v119, v15, v51, v119
  v_dot2_f32_bf16 v116, v16, v52, v116
  v_dot2_f32_bf16 v117, v17, v53, v117
  v_dot2_f32_bf16 v118, v18, v54, v118
  v_dot2_f32_bf16 v119, v19, v55, v119
  v_dot2_f32_bf16 v116, v20, v56, v116
  v_dot2_f32_bf16 v117, v21, v57, v117
  v_dot2_f32_bf16 v118, v22, v58, v118
  v_dot2_f32_bf16 v119, v23, v59, v119
  v_dot2_f32_bf16 v116, v24, v60, v116
  v_dot2_f32_bf16 v117, v25, v61, v117
  v_dot2_f32_bf16 v118, v26, v62, v118
  v_dot2_f32_bf16 v119, v27, v63, v119
  v_dot2_f32_bf16 v116, v28, v64, v116
  v_dot2_f32_bf16 v117, v29, v65, v117
  v_dot2_f32_bf16 v118, v30, v66, v118
  v_dot2_f32_bf16 v119, v31, v67, v119
  v_dot2_f32_bf16 v116, v32, v68, v116
  v_dot2_f32_bf16 v117, v33, v69, v117
  v_dot2_f32_bf16 v118, v34, v70, v118
  v_dot2_f32_bf16 v119, v35, v71, v119
  v_dot2_f32_bf16 v116, v36, v72, v116
  v_dot2_f32_bf16 v117, v37, v73, v117
  v_dot2_f32_bf16 v118, v38, v74, v118
  v_dot2_f32_bf16 v119, v39, v75, v119
  v_dot2_f32_bf16 v116, v40, v76, v116
  v_dot2_f32_bf16 v117, v41, v77, v117
  v_dot2_f32_bf16 v118, v42, v78, v118
  v_dot2_f32_bf16 v119, v43, v79, v119
  s_nop 1
  s_nop 0
  v_pk_add_f32 v[116:117], v[116:117], v[118:119]
  v_add_f32 v5, v116, v117
  s_nop 1
  v_add_f32_dpp v5, v5, v5 quad_perm:[1,0,3,2] row_mask:0xf bank_mask:0xf
  s_nop 1
  v_add_f32_dpp v5, v5, v5 quad_perm:[2,3,0,1] row_mask:0xf bank_mask:0xf
  s_nop 1
  v_add_f32_dpp v5, v5, v5 row_half_mirror row_mask:0xf bank_mask:0xf
  v_cvt_pk_bf16_f32 v5, v5, v5
  v_lshlrev_b32 v5, 16, v5
  v_ashrrev_i32 v7, 31, v5
  v_or_b32 v7, 0x80000000, v7
  v_xor_b32 v7, v7, v5
  v_and_b32 v7, 0xffff0000, v7
  v_sub_u32 v6, 0x7ff, v1
  v_or_b32 v7, v7, v6
  v_mov_b32 v5, 1
  s_mov_b32 s54, 0x01010101
  s_mov_b32 exec_lo, s54
  s_mov_b32 exec_hi, s54
  ds_max_u32 v154, v7 offset:64
  s_mov_b64 exec, 1
  ds_add_rtn_u32 v5, v154, v5 offset:68
  ds_read_b32 v7, v154 offset:64
  s_lshl_b32 s53, s36, 3
  s_add_u32 s53, s53, 10354688
  v_mov_b32 v4, s53
  v_mov_b32 v6, s65
  s_waitcnt lgkmcnt(0)
  v_cmp_eq_u32 vcc, 3, v5
  s_nop 0
  s_and_b64 exec, exec, vcc
  s_cbranch_execz L_sp_nopub
  global_store_dwordx2 v4, v[6:7], s[8:9] sc1
L_sp_nopub:
  s_mov_b64 exec, -1
  s_mov_b32 s55, 0x3f803f80
  v_lshlrev_b32 v44, 16, v8
  v_and_b32 v45, 0xffff0000, v8
  v_lshlrev_b32 v46, 16, v80
  v_and_b32 v47, 0xffff0000, v80
  v_pk_mul_f32 v[44:45], v[44:45], v[46:47]
  v_cvt_pk_bf16_f32 v44, v44, v45
  v_dot2_f32_bf16 v116, v44, s55, 0
  v_lshlrev_b32 v48, 16, v9
  v_and_b32 v49, 0xffff0000, v9
  v_lshlrev_b32 v50, 16, v81
  v_and_b32 v51, 0xffff0000, v81
  v_pk_mul_f32 v[48:49], v[48:49], v[50:51]
  v_cvt_pk_bf16_f32 v48, v48, v49
  v_dot2_f32_bf16 v117, v48, s55, 0
  v_lshlrev_b32 v52, 16, v10
  v_and_b32 v53, 0xffff0000, v10
  v_lshlrev_b32 v54, 16, v82
  v_and_b32 v55, 0xffff0000, v82
  v_pk_mul_f32 v[52:53], v[52:53], v[54:55]
  v_cvt_pk_bf16_f32 v52, v52, v53
  v_dot2_f32_bf16 v118, v52, s55, 0
  v_lshlrev_b32 v56, 16, v11
  v_and_b32 v57, 0xffff0000, v11
  v_lshlrev_b32 v58, 16, v83
  v_and_b32 v59, 0xffff0000, v83
  v_pk_mul_f32 v[56:57], v[56:57], v[58:59]
  v_cvt_pk_bf16_f32 v56, v56, v57
  v_dot2_f32_bf16 v119, v56, s55, 0
  v_lshlrev_b32 v44, 16, v12
  v_and_b32 v45, 0xffff0000, v12
  v_lshlrev_b32 v46, 16, v84
  v_and_b32 v47, 0xffff0000, v84
  v_pk_mul_f32 v[44:45], v[44:45], v[46:47]
  v_cvt_pk_bf16_f32 v44, v44, v45
  v_dot2_f32_bf16 v116, v44, s55, v116
  v_lshlrev_b32 v48, 16, v13
  v_and_b32 v49, 0xffff0000, v13
  v_lshlrev_b32 v50, 16, v85
  v_and_b32 v51, 0xffff0000, v85
  v_pk_mul_f32 v[48:49], v[48:49], v[50:51]
  v_cvt_pk_bf16_f32 v48, v48, v49
  v_dot2_f32_bf16 v117, v48, s55, v117
  v_lshlrev_b32 v52, 16, v14
  v_and_b32 v53, 0xffff0000, v14
  v_lshlrev_b32 v54, 16, v86
  v_and_b32 v55, 0xffff0000, v86
  v_pk_mul_f32 v[52:53], v[52:53], v[54:55]
  v_cvt_pk_bf16_f32 v52, v52, v53
  v_dot2_f32_bf16 v118, v52, s55, v118
  v_lshlrev_b32 v56, 16, v15
  v_and_b32 v57, 0xffff0000, v15
  v_lshlrev_b32 v58, 16, v87
  v_and_b32 v59, 0xffff0000, v87
  v_pk_mul_f32 v[56:57], v[56:57], v[58:59]
  v_cvt_pk_bf16_f32 v56, v56, v57
  v_dot2_f32_bf16 v119, v56, s55, v119
  v_lshlrev_b32 v44, 16, v16
  v_and_b32 v45, 0xffff0000, v16
  v_lshlrev_b32 v46, 16, v88
  v_and_b32 v47, 0xffff0000, v88
  v_pk_mul_f32 v[44:45], v[44:45], v[46:47]
  v_cvt_pk_bf16_f32 v44, v44, v45
  v_dot2_f32_bf16 v116, v44, s55, v116
  v_lshlrev_b32 v48, 16, v17
  v_and_b32 v49, 0xffff0000, v17
  v_lshlrev_b32 v50, 16, v89
  v_and_b32 v51, 0xffff0000, v89
  v_pk_mul_f32 v[48:49], v[48:49], v[50:51]
  v_cvt_pk_bf16_f32 v48, v48, v49
  v_dot2_f32_bf16 v117, v48, s55, v117
  v_lshlrev_b32 v52, 16, v18
  v_and_b32 v53, 0xffff0000, v18
  v_lshlrev_b32 v54, 16, v90
  v_and_b32 v55, 0xffff0000, v90
  v_pk_mul_f32 v[52:53], v[52:53], v[54:55]
  v_cvt_pk_bf16_f32 v52, v52, v53
  v_dot2_f32_bf16 v118, v52, s55, v118
  v_lshlrev_b32 v56, 16, v19
  v_and_b32 v57, 0xffff0000, v19
  v_lshlrev_b32 v58, 16, v91
  v_and_b32 v59, 0xffff0000, v91
  v_pk_mul_f32 v[56:57], v[56:57], v[58:59]
  v_cvt_pk_bf16_f32 v56, v56, v57
  v_dot2_f32_bf16 v119, v56, s55, v119
  v_lshlrev_b32 v44, 16, v20
  v_and_b32 v45, 0xffff0000, v20
  v_lshlrev_b32 v46, 16, v92
  v_and_b32 v47, 0xffff0000, v92
  v_pk_mul_f32 v[44:45], v[44:45], v[46:47]
  v_cvt_pk_bf16_f32 v44, v44, v45
  v_dot2_f32_bf16 v116, v44, s55, v116
  v_lshlrev_b32 v48, 16, v21
  v_and_b32 v49, 0xffff0000, v21
  v_lshlrev_b32 v50, 16, v93
  v_and_b32 v51, 0xffff0000, v93
  v_pk_mul_f32 v[48:49], v[48:49], v[50:51]
  v_cvt_pk_bf16_f32 v48, v48, v49
  v_dot2_f32_bf16 v117, v48, s55, v117
  v_lshlrev_b32 v52, 16, v22
  v_and_b32 v53, 0xffff0000, v22
  v_lshlrev_b32 v54, 16, v94
  v_and_b32 v55, 0xffff0000, v94
  v_pk_mul_f32 v[52:53], v[52:53], v[54:55]
  v_cvt_pk_bf16_f32 v52, v52, v53
  v_dot2_f32_bf16 v118, v52, s55, v118
  v_lshlrev_b32 v56, 16, v23
  v_and_b32 v57, 0xffff0000, v23
  v_lshlrev_b32 v58, 16, v95
  v_and_b32 v59, 0xffff0000, v95
  v_pk_mul_f32 v[56:57], v[56:57], v[58:59]
  v_cvt_pk_bf16_f32 v56, v56, v57
  v_dot2_f32_bf16 v119, v56, s55, v119
  v_lshlrev_b32 v44, 16, v24
  v_and_b32 v45, 0xffff0000, v24
  v_lshlrev_b32 v46, 16, v96
  v_and_b32 v47, 0xffff0000, v96
  v_pk_mul_f32 v[44:45], v[44:45], v[46:47]
  v_cvt_pk_bf16_f32 v44, v44, v45
  v_dot2_f32_bf16 v116, v44, s55, v116
  v_lshlrev_b32 v48, 16, v25
  v_and_b32 v49, 0xffff0000, v25
  v_lshlrev_b32 v50, 16, v97
  v_and_b32 v51, 0xffff0000, v97
  v_pk_mul_f32 v[48:49], v[48:49], v[50:51]
  v_cvt_pk_bf16_f32 v48, v48, v49
  v_dot2_f32_bf16 v117, v48, s55, v117
  v_lshlrev_b32 v52, 16, v26
  v_and_b32 v53, 0xffff0000, v26
  v_lshlrev_b32 v54, 16, v98
  v_and_b32 v55, 0xffff0000, v98
  v_pk_mul_f32 v[52:53], v[52:53], v[54:55]
  v_cvt_pk_bf16_f32 v52, v52, v53
  v_dot2_f32_bf16 v118, v52, s55, v118
  v_lshlrev_b32 v56, 16, v27
  v_and_b32 v57, 0xffff0000, v27
  v_lshlrev_b32 v58, 16, v99
  v_and_b32 v59, 0xffff0000, v99
  v_pk_mul_f32 v[56:57], v[56:57], v[58:59]
  v_cvt_pk_bf16_f32 v56, v56, v57
  v_dot2_f32_bf16 v119, v56, s55, v119
  v_lshlrev_b32 v44, 16, v28
  v_and_b32 v45, 0xffff0000, v28
  v_lshlrev_b32 v46, 16, v100
  v_and_b32 v47, 0xffff0000, v100
  v_pk_mul_f32 v[44:45], v[44:45], v[46:47]
  v_cvt_pk_bf16_f32 v44, v44, v45
  v_dot2_f32_bf16 v116, v44, s55, v116
  v_lshlrev_b32 v48, 16, v29
  v_and_b32 v49, 0xffff0000, v29
  v_lshlrev_b32 v50, 16, v101
  v_and_b32 v51, 0xffff0000, v101
  v_pk_mul_f32 v[48:49], v[48:49], v[50:51]
  v_cvt_pk_bf16_f32 v48, v48, v49
  v_dot2_f32_bf16 v117, v48, s55, v117
  v_lshlrev_b32 v52, 16, v30
  v_and_b32 v53, 0xffff0000, v30
  v_lshlrev_b32 v54, 16, v102
  v_and_b32 v55, 0xffff0000, v102
  v_pk_mul_f32 v[52:53], v[52:53], v[54:55]
  v_cvt_pk_bf16_f32 v52, v52, v53
  v_dot2_f32_bf16 v118, v52, s55, v118
  v_lshlrev_b32 v56, 16, v31
  v_and_b32 v57, 0xffff0000, v31
  v_lshlrev_b32 v58, 16, v103
  v_and_b32 v59, 0xffff0000, v103
  v_pk_mul_f32 v[56:57], v[56:57], v[58:59]
  v_cvt_pk_bf16_f32 v56, v56, v57
  v_dot2_f32_bf16 v119, v56, s55, v119
  v_lshlrev_b32 v44, 16, v32
  v_and_b32 v45, 0xffff0000, v32
  v_lshlrev_b32 v46, 16, v104
  v_and_b32 v47, 0xffff0000, v104
  v_pk_mul_f32 v[44:45], v[44:45], v[46:47]
  v_cvt_pk_bf16_f32 v44, v44, v45
  v_dot2_f32_bf16 v116, v44, s55, v116
  v_lshlrev_b32 v48, 16, v33
  v_and_b32 v49, 0xffff0000, v33
  v_lshlrev_b32 v50, 16, v105
  v_and_b32 v51, 0xffff0000, v105
  v_pk_mul_f32 v[48:49], v[48:49], v[50:51]
  v_cvt_pk_bf16_f32 v48, v48, v49
  v_dot2_f32_bf16 v117, v48, s55, v117
  v_lshlrev_b32 v52, 16, v34
  v_and_b32 v53, 0xffff0000, v34
  v_lshlrev_b32 v54, 16, v106
  v_and_b32 v55, 0xffff0000, v106
  v_pk_mul_f32 v[52:53], v[52:53], v[54:55]
  v_cvt_pk_bf16_f32 v52, v52, v53
  v_dot2_f32_bf16 v118, v52, s55, v118
  v_lshlrev_b32 v56, 16, v35
  v_and_b32 v57, 0xffff0000, v35
  v_lshlrev_b32 v58, 16, v107
  v_and_b32 v59, 0xffff0000, v107
  v_pk_mul_f32 v[56:57], v[56:57], v[58:59]
  v_cvt_pk_bf16_f32 v56, v56, v57
  v_dot2_f32_bf16 v119, v56, s55, v119
  v_lshlrev_b32 v44, 16, v36
  v_and_b32 v45, 0xffff0000, v36
  v_lshlrev_b32 v46, 16, v108
  v_and_b32 v47, 0xffff0000, v108
  v_pk_mul_f32 v[44:45], v[44:45], v[46:47]
  v_cvt_pk_bf16_f32 v44, v44, v45
  v_dot2_f32_bf16 v116, v44, s55, v116
  v_lshlrev_b32 v48, 16, v37
  v_and_b32 v49, 0xffff0000, v37
  v_lshlrev_b32 v50, 16, v109
  v_and_b32 v51, 0xffff0000, v109
  v_pk_mul_f32 v[48:49], v[48:49], v[50:51]
  v_cvt_pk_bf16_f32 v48, v48, v49
  v_dot2_f32_bf16 v117, v48, s55, v117
  v_lshlrev_b32 v52, 16, v38
  v_and_b32 v53, 0xffff0000, v38
  v_lshlrev_b32 v54, 16, v110
  v_and_b32 v55, 0xffff0000, v110
  v_pk_mul_f32 v[52:53], v[52:53], v[54:55]
  v_cvt_pk_bf16_f32 v52, v52, v53
  v_dot2_f32_bf16 v118, v52, s55, v118
  v_lshlrev_b32 v56, 16, v39
  v_and_b32 v57, 0xffff0000, v39
  v_lshlrev_b32 v58, 16, v111
  v_and_b32 v59, 0xffff0000, v111
  v_pk_mul_f32 v[56:57], v[56:57], v[58:59]
  v_cvt_pk_bf16_f32 v56, v56, v57
  v_dot2_f32_bf16 v119, v56, s55, v119
  v_lshlrev_b32 v44, 16, v40
  v_and_b32 v45, 0xffff0000, v40
  v_lshlrev_b32 v46, 16, v112
  v_and_b32 v47, 0xffff0000, v112
  v_pk_mul_f32 v[44:45], v[44:45], v[46:47]
  v_cvt_pk_bf16_f32 v44, v44, v45
  v_dot2_f32_bf16 v116, v44, s55, v116
  v_lshlrev_b32 v48, 16, v41
  v_and_b32 v49, 0xffff0000, v41
  v_lshlrev_b32 v50, 16, v113
  v_and_b32 v51, 0xffff0000, v113
  v_pk_mul_f32 v[48:49], v[48:49], v[50:51]
  v_cvt_pk_bf16_f32 v48, v48, v49
  v_dot2_f32_bf16 v117, v48, s55, v117
  v_lshlrev_b32 v52, 16, v42
  v_and_b32 v53, 0xffff0000, v42
  v_lshlrev_b32 v54, 16, v114
  v_and_b32 v55, 0xffff0000, v114
  v_pk_mul_f32 v[52:53], v[52:53], v[54:55]
  v_cvt_pk_bf16_f32 v52, v52, v53
  v_dot2_f32_bf16 v118, v52, s55, v118
  v_lshlrev_b32 v56, 16, v43
  v_and_b32 v57, 0xffff0000, v43
  v_lshlrev_b32 v58, 16, v115
  v_and_b32 v59, 0xffff0000, v115
  v_pk_mul_f32 v[56:57], v[56:57], v[58:59]
  v_cvt_pk_bf16_f32 v56, v56, v57
  v_dot2_f32_bf16 v119, v56, s55, v119
  s_nop 1
  s_nop 0
  v_pk_add_f32 v[116:117], v[116:117], v[118:119]
  v_add_f32 v6, v116, v117
  s_nop 1
  v_add_f32_dpp v6, v6, v6 quad_perm:[1,0,3,2] row_mask:0xf bank_mask:0xf
  s_nop 1
  v_add_f32_dpp v6, v6, v6 quad_perm:[2,3,0,1] row_mask:0xf bank_mask:0xf
  s_nop 1
  v_add_f32_dpp v6, v6, v6 row_half_mirror row_mask:0xf bank_mask:0xf
  v_cvt_pk_bf16_f32 v6, v6, v6
  v_lshlrev_b32 v6, 16, v6
  v_mul_f32 v6, 0xbfb8aa3b, v6
  v_exp_f32 v6, v6
  s_nop 0
  v_add_f32 v6, 1.0, v6
  v_rcp_f32 v6, v6
  s_nop 0
  v_cvt_pk_bf16_f32 v6, v6, v6
  v_lshlrev_b32 v6, 16, v6
  v_lshlrev_b32 v1, 2, v1
  v_add_u32 v1, 9977856, v1
  s_mov_b32 exec_lo, s54
  s_mov_b32 exec_hi, s54
  global_store_dword v1, v6, s[8:9] sc1
  s_mov_b64 exec, -1
  s_waitcnt vmcnt(0)
  v_mov_b32 v5, 1
  s_mov_b64 exec, 1
  ds_add_u32 v154, v5 offset:76
  s_mov_b64 exec, -1
  s_mov_b32 s63, 0
  s_branch L_att
L_sp_hi:
  s_cmp_eq_u32 s3, 7
  s_cbranch_scc0 L_sp_hi1
  s_getpc_b64 s[20:21]
L_pc_1:
  s_sub_u32 s20, s20, L_pc_1-gated_mix__sliding_block__moe_arch_mod__prompt_kernel
  s_subb_u32 s21, s21, 0
  s_lshr_b32 s22, s2, 3
  s_mul_i32 s22, s22, 1536
  v_lshlrev_b32 v20, 7, v0
  v_add_u32 v20, s22, v20
  v_min_u32 v20, L_end-gated_mix__sliding_block__moe_arch_mod__prompt_kernel, v20
  s_mov_b64 exec, 0xfff
  global_load_dword v21, v20, s[20:21]
  s_mov_b64 exec, -1
L_sp_hi1:
  v_mov_b32 v154, 149568
  s_waitcnt lgkmcnt(0)
  s_mov_b32 s64, 10371072
  s_load_dword s65, s[8:9], s64
  s_mov_b32 s63, 0
  s_waitcnt lgkmcnt(0)
  s_mul_i32 s65, s65, 0x9e3779b1
  s_add_u32 s65, s65, 0x7f4a7c15
  s_barrier
  s_cmp_eq_u32 s3, 4
  s_cbranch_scc1 L_sp_w4
  s_cmp_eq_u32 s3, 5
  s_cbranch_scc0 L_att
  s_lshl_b32 s56, s36, 7
  s_add_u32 s56, s56, 10280960
  v_mov_b32 v9, s56
  s_mov_b32 s60, 0x200000
L_sp_x5:
  ds_read_b64 v[10:11], v154 offset:72
  s_waitcnt lgkmcnt(0)
  v_readfirstlane_b32 s61, v10
  v_readfirstlane_b32 s62, v11
  s_nop 0
  s_lshl_b32 s62, s62, 8
  s_or_b32 s61, s61, s62
  s_cmp_eq_u32 s61, 1025
  s_cbranch_scc1 L_sp_x5_d
  s_sleep 4
  s_sub_u32 s60, s60, 1
  s_cmp_lg_u32 s60, 0
  s_cbranch_scc1 L_sp_x5
L_sp_x5_d:
  ds_read_b64 v[14:15], v154 offset:56
  v_mov_b32 v12, s65
  s_waitcnt lgkmcnt(0)
  v_mov_b32 v13, v14
  v_mov_b32 v14, v15
  s_mov_b64 exec, 1
  global_store_dwordx3 v9, v[12:14], s[8:9] sc1
  s_mov_b64 exec, -1
  s_branch L_att
L_sp_w4:
  v_mov_b32 v12, 0
  v_mov_b32 v13, 0
  v_mov_b32 v14, 0
  v_mov_b32 v15, 0
  s_cmp_lt_u32 s36, 36
  s_cbranch_scc0 L_sp_nz
  s_lshl_b32 s51, s36, 10
  s_add_u32 s51, s51, 10092544
  v_lshlrev_b32 v4, 4, v0
  v_add_u32 v4, s51, v4
  global_store_dwordx4 v4, v[12:15], s[8:9] sc1
  s_cmp_eq_u32 s36, 0
  s_cbranch_scc0 L_sp_nz
  v_lshlrev_b32 v4, 7, v0
  v_add_u32 v4, 10289152, v4
  global_store_dword v4, v12, s[8:9] sc1
L_sp_nz:
  v_lshlrev_b32 v8, 3, v0
  v_add_u32 v8, 10354688, v8
  s_mov_b32 s60, 0x200000
L_sp_own:
  ds_read_b32 v10, v154 offset:68
  s_waitcnt lgkmcnt(0)
  v_readfirstlane_b32 s61, v10
  s_nop 0
  s_cmp_eq_u32 s61, 4
  s_cbranch_scc1 L_sp_own_d
  s_sleep 2
  s_sub_u32 s60, s60, 1
  s_cmp_lg_u32 s60, 0
  s_cbranch_scc1 L_sp_own
L_sp_own_d:
  s_sleep 24
  s_mov_b64 exec, -1
  s_mov_b32 s60, 0x40000
L_sp_kp:
  global_load_dwordx2 v[10:11], v8, s[8:9] sc1
  s_waitcnt vmcnt(0)
  v_cmp_eq_u32 vcc, s65, v10
  s_nop 0
  s_cmp_eq_u64 vcc, exec
  s_cbranch_scc1 L_sp_kp_d
  s_sleep 8
  s_sub_u32 s60, s60, 1
  s_cmp_lg_u32 s60, 0
  s_cbranch_scc1 L_sp_kp
L_sp_kp_d:
  s_mov_b64 exec, -1
  v_max_u32_dpp v11, v11, v11 row_shr:1 row_mask:0xf bank_mask:0xf
  s_nop 1
  v_max_u32_dpp v11, v11, v11 row_shr:2 row_mask:0xf bank_mask:0xf
  s_nop 1
  v_max_u32_dpp v11, v11, v11 row_shr:4 row_mask:0xf bank_mask:0xf
  s_nop 1
  v_max_u32_dpp v11, v11, v11 row_shr:8 row_mask:0xf bank_mask:0xf
  s_nop 1
  v_max_u32_dpp v11, v11, v11 row_bcast:15 row_mask:0xa bank_mask:0xf
  s_nop 1
  v_max_u32_dpp v11, v11, v11 row_bcast:31 row_mask:0xc bank_mask:0xf
  s_nop 0
  v_readlane_b32 s53, v11, 63
  s_nop 0
  s_and_b32 s54, s53, 0x7ff
  s_sub_u32 s54, 2047, s54
  v_mov_b32 v12, s54
  v_mov_b32 v13, 1
  ds_write_b32 v154, v12 offset:56
  ds_write_b32 v154, v13 offset:20
  s_and_b32 s55, s53, 0xffff0000
  s_xor_b32 s56, s55, 0x80000000
  s_xor_b32 s57, s55, 0xffff0000
  s_bitcmp1_b32 s55, 31
  s_cselect_b32 s55, s56, s57
  v_mov_b32 v12, s55
  v_mul_f32 v13, 0xbfb8aa3b, v12
  v_exp_f32 v13, v13
  s_nop 0
  v_add_f32 v13, 1.0, v13
  v_rcp_f32 v13, v13
  s_nop 0
  v_cvt_pk_bf16_f32 v13, v13, v13
  v_lshlrev_b32 v13, 16, v13
  v_mov_b32 v12, s54
  ds_write_b64 v154, v[12:13] offset:56
  v_mov_b32 v12, 1
  s_waitcnt vmcnt(0)
  ds_write_b32 v154, v12 offset:72
  s_branch L_att
L_sp_ffn:
  s_load_dwordx4 s[40:43], s[0:1], 40
  v_mov_b32 v3, 149568
  v_mov_b32 v4, 0
  v_mov_b32 v5, 0
  v_mov_b32 v6, 0
  v_mov_b32 v7, 0
  v_lshlrev_b32 v1, 4, v0
  v_add_u32 v2, v1, v3
  s_mov_b64 exec, 0xff
  ds_write_b128 v2, v[4:7]
  s_mov_b64 exec, -1
  s_sub_u32 s59, s3, 8
  s_mul_i32 s37, s36, 57
  s_lshr_b32 s37, s37, 9
  s_mul_i32 s38, s37, 9
  s_sub_u32 s38, s36, s38
  s_mul_i32 s49, s37, 84
  s_mul_i32 s39, s49, 9216
  s_lshl_b32 s48, s38, 10
  s_add_u32 s39, s39, s48
  s_sub_u32 s48, 5308416, s39
  s_min_i32 s48, s48, 765952
  s_max_i32 s48, s48, 0
  v_lshrrev_b32 v160, 5, v0
  v_mul_u32_u24 v160, 9216, v160
  v_and_b32 v161, 31, v0
  v_lshl_add_u32 v160, v161, 4, v160
  s_mul_i32 s57, s59, 20480
  s_add_u32 s57, s57, 66560
  s_mul_i32 s58, s59, 18432
  s_waitcnt lgkmcnt(0)
  s_mov_b32 s64, 10371072
  s_load_dword s65, s[8:9], s64
  s_add_u32 s16, s40, s39
  s_addc_u32 s17, s41, 0
  s_and_b32 s17, s17, 0xffff
  s_mov_b32 s18, s48
  s_mov_b32 s19, 0x20000
  s_add_u32 s20, s42, s39
  s_addc_u32 s21, s43, 0
  s_and_b32 s21, s21, 0xffff
  s_mov_b32 s22, s48
  s_mov_b32 s23, 0x20000
  s_waitcnt lgkmcnt(0)
  s_mul_i32 s65, s65, 0x9e3779b1
  s_add_u32 s65, s65, 0x7f4a7c15
  s_barrier
  s_add_u32 s55, s58, 442368
  s_add_u32 s56, s55, 512
  s_add_u32 m0, s57, 0
  s_nop 0
  buffer_load_dwordx4 v160, s[16:19], s55 offen nt lds
  s_add_u32 m0, s57, 1024
  s_nop 0
  buffer_load_dwordx4 v160, s[16:19], s56 offen nt lds
  s_add_u32 m0, s57, 2048
  s_nop 0
  buffer_load_dwordx4 v160, s[20:23], s55 offen nt lds
  s_add_u32 m0, s57, 3072
  s_nop 0
  buffer_load_dwordx4 v160, s[20:23], s56 offen nt lds
  s_add_u32 s55, s58, 516096
  s_add_u32 s56, s55, 512
  s_add_u32 m0, s57, 4096
  s_nop 0
  buffer_load_dwordx4 v160, s[16:19], s55 offen nt lds
  s_add_u32 m0, s57, 5120
  s_nop 0
  buffer_load_dwordx4 v160, s[16:19], s56 offen nt lds
  s_add_u32 m0, s57, 6144
  s_nop 0
  buffer_load_dwordx4 v160, s[20:23], s55 offen nt lds
  s_add_u32 m0, s57, 7168
  s_nop 0
  buffer_load_dwordx4 v160, s[20:23], s56 offen nt lds
  s_waitcnt vmcnt(7)
  s_add_u32 s55, s58, 589824
  s_add_u32 s56, s55, 512
  s_add_u32 m0, s57, 8192
  s_nop 0
  buffer_load_dwordx4 v160, s[16:19], s55 offen nt lds
  s_waitcnt vmcnt(7)
  s_add_u32 m0, s57, 9216
  s_nop 0
  buffer_load_dwordx4 v160, s[16:19], s56 offen nt lds
  s_waitcnt vmcnt(7)
  s_add_u32 m0, s57, 10240
  s_nop 0
  buffer_load_dwordx4 v160, s[20:23], s55 offen nt lds
  s_waitcnt vmcnt(7)
  s_add_u32 m0, s57, 11264
  s_nop 0
  buffer_load_dwordx4 v160, s[20:23], s56 offen nt lds
  s_waitcnt vmcnt(7)
  s_add_u32 s55, s58, 663552
  s_add_u32 s56, s55, 512
  s_add_u32 m0, s57, 12288
  s_nop 0
  buffer_load_dwordx4 v160, s[16:19], s55 offen nt lds
  s_waitcnt vmcnt(7)
  s_add_u32 m0, s57, 13312
  s_nop 0
  buffer_load_dwordx4 v160, s[16:19], s56 offen nt lds
  s_waitcnt vmcnt(7)
  s_add_u32 m0, s57, 14336
  s_nop 0
  buffer_load_dwordx4 v160, s[20:23], s55 offen nt lds
  s_waitcnt vmcnt(7)
  s_add_u32 m0, s57, 15360
  s_nop 0
  buffer_load_dwordx4 v160, s[20:23], s56 offen nt lds
  s_waitcnt vmcnt(7)
  s_add_u32 s55, s58, 737280
  s_add_u32 s56, s55, 512
  s_add_u32 m0, s57, 16384
  s_nop 0
  buffer_load_dwordx4 v160, s[16:19], s55 offen nt lds
  s_waitcnt vmcnt(7)
  s_add_u32 m0, s57, 17408
  s_nop 0
  buffer_load_dwordx4 v160, s[16:19], s56 offen nt lds
  s_waitcnt vmcnt(7)
  s_add_u32 m0, s57, 18432
  s_nop 0
  buffer_load_dwordx4 v160, s[20:23], s55 offen nt lds
  s_waitcnt vmcnt(7)
  s_add_u32 m0, s57, 19456
  s_nop 0
  buffer_load_dwordx4 v160, s[20:23], s56 offen nt lds
  s_waitcnt vmcnt(7)
  s_add_u32 s55, s58, 0
  buffer_load_dwordx4 v[64:67], v160, s[16:19], s55 offen offset:0 nt
  s_waitcnt vmcnt(7)
  buffer_load_dwordx4 v[68:71], v160, s[16:19], s55 offen offset:512 nt
  s_waitcnt vmcnt(7)
  buffer_load_dwordx4 v[72:75], v160, s[20:23], s55 offen offset:0 nt
  s_waitcnt vmcnt(7)
  buffer_load_dwordx4 v[76:79], v160, s[20:23], s55 offen offset:512 nt
  s_waitcnt vmcnt(7)
  s_add_u32 s55, s58, 73728
  buffer_load_dwordx4 v[80:83], v160, s[16:19], s55 offen offset:0 nt
  s_waitcnt vmcnt(7)
  buffer_load_dwordx4 v[84:87], v160, s[16:19], s55 offen offset:512 nt
  s_waitcnt vmcnt(7)
  buffer_load_dwordx4 v[88:91], v160, s[20:23], s55 offen offset:0 nt
  s_waitcnt vmcnt(7)
  buffer_load_dwordx4 v[92:95], v160, s[20:23], s55 offen offset:512 nt
  s_waitcnt vmcnt(7)
  s_add_u32 s55, s58, 147456
  buffer_load_dwordx4 v[96:99], v160, s[16:19], s55 offen offset:0 nt
  s_waitcnt vmcnt(7)
  buffer_load_dwordx4 v[100:103], v160, s[16:19], s55 offen offset:512 nt
  s_waitcnt vmcnt(7)
  buffer_load_dwordx4 v[104:107], v160, s[20:23], s55 offen offset:0 nt
  buffer_load_dwordx4 v[108:111], v160, s[20:23], s55 offen offset:512 nt
  s_add_u32 s55, s58, 221184
  buffer_load_dwordx4 v[112:115], v160, s[16:19], s55 offen offset:0 nt
  buffer_load_dwordx4 v[116:119], v160, s[16:19], s55 offen offset:512 nt
  buffer_load_dwordx4 v[120:123], v160, s[20:23], s55 offen offset:0 nt
  buffer_load_dwordx4 v[124:127], v160, s[20:23], s55 offen offset:512 nt
  s_add_u32 s55, s58, 294912
  buffer_load_dwordx4 v[128:131], v160, s[16:19], s55 offen offset:0 nt
  buffer_load_dwordx4 v[132:135], v160, s[16:19], s55 offen offset:512 nt
  buffer_load_dwordx4 v[136:139], v160, s[20:23], s55 offen offset:0 nt
  buffer_load_dwordx4 v[140:143], v160, s[20:23], s55 offen offset:512 nt
  s_add_u32 s55, s58, 368640
  buffer_load_dwordx4 v[144:147], v160, s[16:19], s55 offen offset:0 nt
  buffer_load_dwordx4 v[148:151], v160, s[16:19], s55 offen offset:512 nt
  buffer_load_dwordx4 v[152:155], v160, s[20:23], s55 offen offset:0 nt
  buffer_load_dwordx4 v[156:159], v160, s[20:23], s55 offen offset:512 nt
  s_lshl_b32 s50, s59, 1
  s_add_u32 s50, s50, s49
  s_lshl_b32 s50, s50, 1
  v_lshrrev_b32 v51, 5, v0
  v_lshlrev_b32 v51, 4, v51
  v_and_b32 v2, 1, v0
  v_lshlrev_b32 v2, 4, v2
  v_lshrrev_b32 v4, 1, v0
  v_xor_b32 v4, v4, v0
  v_and_b32 v4, 8, v4
  v_bfe_u32 v5, v0, 1, 2
  v_or_b32 v4, v4, v5
  v_cmp_eq_u32 s[40:41], 0, v4
  v_cmp_eq_u32 s[42:43], 1, v4
  v_cmp_eq_u32 s[44:45], 2, v4
  v_cmp_eq_u32 s[46:47], 3, v4
  v_bfe_u32 v4, v0, 3, 1
  v_lshlrev_b32 v4, 9, v4
  v_lshrrev_b32 v5, 4, v0
  v_lshl_add_u32 v4, v5, 7, v4
  v_and_b32 v5, 7, v0
  v_lshl_add_u32 v4, v5, 2, v4
  v_add_u32 v6, s57, v4
  v_add_u32 v52, s57, v1
  s_lshl_b32 s55, s59, 9
  v_lshlrev_b32 v8, 3, v0
  v_add_u32 v8, s55, v8
  s_mul_i32 s52, s37, 73728
  s_lshl_b32 s55, s38, 13
  s_add_u32 s52, s52, s55
  s_add_u32 s52, s52, 11534336
  v_lshlrev_b32 v9, 2, v8
  v_add_u32 v9, s52, v9
  v_add_u32 v8, 66560, v8
  s_mov_b32 s60, 0x200000
L_sp_xs:
  ds_read_b32 v10, v3 offset:20
  s_waitcnt lgkmcnt(0)
  v_readfirstlane_b32 s61, v10
  s_nop 0
  s_cmp_eq_u32 s61, 1
  s_cbranch_scc1 L_sp_xs_d
  s_sleep 1
  s_sub_u32 s60, s60, 1
  s_cmp_lg_u32 s60, 0
  s_cbranch_scc1 L_sp_xs
L_sp_xs_d:
  s_setprio 3
  ds_read_b32 v10, v3 offset:56
  s_waitcnt lgkmcnt(0)
  v_readfirstlane_b32 s51, v10
  s_nop 0
  s_mul_i32 s51, s51, 1152
  s_add_u32 s24, s4, s51
  s_addc_u32 s25, s5, 0
  s_and_b32 s25, s25, 0xffff
  s_mov_b32 s26, 1152
  s_mov_b32 s27, 0x20000
  s_mov_b32 s51, s50
  s_buffer_load_dword s30, s[24:27], s51 offset:0
  s_buffer_load_dword s31, s[24:27], s51 offset:16
  s_buffer_load_dword s32, s[24:27], s51 offset:32
  s_buffer_load_dword s33, s[24:27], s51 offset:48
  s_buffer_load_dword s34, s[24:27], s51 offset:64
  s_buffer_load_dword s35, s[24:27], s51 offset:80
  s_buffer_load_dword s39, s[24:27], s51 offset:96
  s_buffer_load_dword s48, s[24:27], s51 offset:112
  s_buffer_load_dword s49, s[24:27], s51 offset:128
  s_buffer_load_dword s50, s[24:27], s51 offset:144
  s_buffer_load_dword s53, s[24:27], s51 offset:160
  s_waitcnt vmcnt(24) lgkmcnt(0)
  ds_read_b128 v[32:35], v52 offset:0
  ds_read_b128 v[36:39], v52 offset:1024
  ds_read_b128 v[40:43], v52 offset:2048
  ds_read_b128 v[44:47], v52 offset:3072
  v_bfe_u32 v53, s30, v51, 16
  v_lshlrev_b32 v53, v2, v53
  v_bfe_u32 v54, s31, v51, 16
  v_lshlrev_b32 v54, v2, v54
  v_bfe_u32 v55, s32, v51, 16
  v_lshlrev_b32 v55, v2, v55
  v_bfe_u32 v56, s33, v51, 16
  v_lshlrev_b32 v56, v2, v56
  v_bfe_u32 v57, s34, v51, 16
  v_lshlrev_b32 v57, v2, v57
  v_bfe_u32 v58, s35, v51, 16
  v_lshlrev_b32 v58, v2, v58
  v_bfe_u32 v59, s39, v51, 16
  v_lshlrev_b32 v59, v2, v59
  v_bfe_u32 v60, s48, v51, 16
  v_lshlrev_b32 v60, v2, v60
  v_bfe_u32 v61, s49, v51, 16
  v_lshlrev_b32 v61, v2, v61
  v_bfe_u32 v62, s50, v51, 16
  v_lshlrev_b32 v62, v2, v62
  v_bfe_u32 v63, s53, v51, 16
  v_lshlrev_b32 v63, v2, v63
  v_cndmask_b32 v12, 0, v59, s[40:41]
  v_cndmask_b32 v13, 0, v59, s[42:43]
  v_cndmask_b32 v14, 0, v59, s[44:45]
  v_cndmask_b32 v15, 0, v59, s[46:47]
  s_waitcnt lgkmcnt(3)
  s_nop 0
  v_mfma_f32_16x16x32_bf16 v[16:19], v[32:35], v[12:15], 0
  ds_read_b128 v[32:35], v52 offset:4096
  s_waitcnt lgkmcnt(3)
  v_mfma_f32_16x16x32_bf16 v[20:23], v[36:39], v[12:15], 0
  ds_read_b128 v[36:39], v52 offset:5120
  s_waitcnt lgkmcnt(3)
  v_mfma_f32_16x16x32_bf16 v[24:27], v[40:43], v[12:15], 0
  ds_read_b128 v[40:43], v52 offset:6144
  s_waitcnt lgkmcnt(3)
  v_mfma_f32_16x16x32_bf16 v[28:31], v[44:47], v[12:15], 0
  ds_read_b128 v[44:47], v52 offset:7168
  v_cndmask_b32 v12, 0, v60, s[40:41]
  v_cndmask_b32 v13, 0, v60, s[42:43]
  v_cndmask_b32 v14, 0, v60, s[44:45]
  v_cndmask_b32 v15, 0, v60, s[46:47]
  s_waitcnt lgkmcnt(3)
  s_nop 0
  v_mfma_f32_16x16x32_bf16 v[16:19], v[32:35], v[12:15], v[16:19]
  ds_read_b128 v[32:35], v52 offset:8192
  s_waitcnt lgkmcnt(3)
  v_mfma_f32_16x16x32_bf16 v[20:23], v[36:39], v[12:15], v[20:23]
  ds_read_b128 v[36:39], v52 offset:9216
  s_waitcnt lgkmcnt(3)
  v_mfma_f32_16x16x32_bf16 v[24:27], v[40:43], v[12:15], v[24:27]
  ds_read_b128 v[40:43], v52 offset:10240
  s_waitcnt lgkmcnt(3)
  v_mfma_f32_16x16x32_bf16 v[28:31], v[44:47], v[12:15], v[28:31]
  ds_read_b128 v[44:47], v52 offset:11264
  v_cndmask_b32 v12, 0, v61, s[40:41]
  v_cndmask_b32 v13, 0, v61, s[42:43]
  v_cndmask_b32 v14, 0, v61, s[44:45]
  v_cndmask_b32 v15, 0, v61, s[46:47]
  s_waitcnt lgkmcnt(3)
  s_nop 0
  v_mfma_f32_16x16x32_bf16 v[16:19], v[32:35], v[12:15], v[16:19]
  ds_read_b128 v[32:35], v52 offset:12288
  s_waitcnt lgkmcnt(3)
  v_mfma_f32_16x16x32_bf16 v[20:23], v[36:39], v[12:15], v[20:23]
  ds_read_b128 v[36:39], v52 offset:13312
  s_waitcnt lgkmcnt(3)
  v_mfma_f32_16x16x32_bf16 v[24:27], v[40:43], v[12:15], v[24:27]
  ds_read_b128 v[40:43], v52 offset:14336
  s_waitcnt lgkmcnt(3)
  v_mfma_f32_16x16x32_bf16 v[28:31], v[44:47], v[12:15], v[28:31]
  ds_read_b128 v[44:47], v52 offset:15360
  v_cndmask_b32 v12, 0, v62, s[40:41]
  v_cndmask_b32 v13, 0, v62, s[42:43]
  v_cndmask_b32 v14, 0, v62, s[44:45]
  v_cndmask_b32 v15, 0, v62, s[46:47]
  s_waitcnt lgkmcnt(3)
  s_nop 0
  v_mfma_f32_16x16x32_bf16 v[16:19], v[32:35], v[12:15], v[16:19]
  ds_read_b128 v[32:35], v52 offset:16384
  s_waitcnt lgkmcnt(3)
  v_mfma_f32_16x16x32_bf16 v[20:23], v[36:39], v[12:15], v[20:23]
  ds_read_b128 v[36:39], v52 offset:17408
  s_waitcnt lgkmcnt(3)
  v_mfma_f32_16x16x32_bf16 v[24:27], v[40:43], v[12:15], v[24:27]
  ds_read_b128 v[40:43], v52 offset:18432
  s_waitcnt lgkmcnt(3)
  v_mfma_f32_16x16x32_bf16 v[28:31], v[44:47], v[12:15], v[28:31]
  ds_read_b128 v[44:47], v52 offset:19456
  v_cndmask_b32 v12, 0, v63, s[40:41]
  v_cndmask_b32 v13, 0, v63, s[42:43]
  v_cndmask_b32 v14, 0, v63, s[44:45]
  v_cndmask_b32 v15, 0, v63, s[46:47]
  s_waitcnt lgkmcnt(3)
  s_nop 0
  v_mfma_f32_16x16x32_bf16 v[16:19], v[32:35], v[12:15], v[16:19]
  s_waitcnt lgkmcnt(2)
  v_mfma_f32_16x16x32_bf16 v[20:23], v[36:39], v[12:15], v[20:23]
  s_waitcnt lgkmcnt(1)
  v_mfma_f32_16x16x32_bf16 v[24:27], v[40:43], v[12:15], v[24:27]
  s_waitcnt lgkmcnt(0)
  v_mfma_f32_16x16x32_bf16 v[28:31], v[44:47], v[12:15], v[28:31]
  v_cndmask_b32 v12, 0, v53, s[40:41]
  v_cndmask_b32 v13, 0, v53, s[42:43]
  v_cndmask_b32 v14, 0, v53, s[44:45]
  v_cndmask_b32 v15, 0, v53, s[46:47]
  s_waitcnt vmcnt(20)
  s_nop 0
  v_mfma_f32_16x16x32_bf16 v[16:19], v[64:67], v[12:15], v[16:19]
  v_mfma_f32_16x16x32_bf16 v[20:23], v[68:71], v[12:15], v[20:23]
  v_mfma_f32_16x16x32_bf16 v[24:27], v[72:75], v[12:15], v[24:27]
  v_mfma_f32_16x16x32_bf16 v[28:31], v[76:79], v[12:15], v[28:31]
  v_cndmask_b32 v12, 0, v54, s[40:41]
  v_cndmask_b32 v13, 0, v54, s[42:43]
  v_cndmask_b32 v14, 0, v54, s[44:45]
  v_cndmask_b32 v15, 0, v54, s[46:47]
  s_waitcnt vmcnt(16)
  s_nop 0
  v_mfma_f32_16x16x32_bf16 v[16:19], v[80:83], v[12:15], v[16:19]
  v_mfma_f32_16x16x32_bf16 v[20:23], v[84:87], v[12:15], v[20:23]
  v_mfma_f32_16x16x32_bf16 v[24:27], v[88:91], v[12:15], v[24:27]
  v_mfma_f32_16x16x32_bf16 v[28:31], v[92:95], v[12:15], v[28:31]
  v_cndmask_b32 v12, 0, v55, s[40:41]
  v_cndmask_b32 v13, 0, v55, s[42:43]
  v_cndmask_b32 v14, 0, v55, s[44:45]
  v_cndmask_b32 v15, 0, v55, s[46:47]
  s_waitcnt vmcnt(12)
  s_nop 0
  v_mfma_f32_16x16x32_bf16 v[16:19], v[96:99], v[12:15], v[16:19]
  v_mfma_f32_16x16x32_bf16 v[20:23], v[100:103], v[12:15], v[20:23]
  v_mfma_f32_16x16x32_bf16 v[24:27], v[104:107], v[12:15], v[24:27]
  v_mfma_f32_16x16x32_bf16 v[28:31], v[108:111], v[12:15], v[28:31]
  v_cndmask_b32 v12, 0, v56, s[40:41]
  v_cndmask_b32 v13, 0, v56, s[42:43]
  v_cndmask_b32 v14, 0, v56, s[44:45]
  v_cndmask_b32 v15, 0, v56, s[46:47]
  s_waitcnt vmcnt(8)
  s_nop 0
  v_mfma_f32_16x16x32_bf16 v[16:19], v[112:115], v[12:15], v[16:19]
  v_mfma_f32_16x16x32_bf16 v[20:23], v[116:119], v[12:15], v[20:23]
  v_mfma_f32_16x16x32_bf16 v[24:27], v[120:123], v[12:15], v[24:27]
  v_mfma_f32_16x16x32_bf16 v[28:31], v[124:127], v[12:15], v[28:31]
  v_cndmask_b32 v12, 0, v57, s[40:41]
  v_cndmask_b32 v13, 0, v57, s[42:43]
  v_cndmask_b32 v14, 0, v57, s[44:45]
  v_cndmask_b32 v15, 0, v57, s[46:47]
  s_waitcnt vmcnt(4)
  s_nop 0
  v_mfma_f32_16x16x32_bf16 v[16:19], v[128:131], v[12:15], v[16:19]
  v_mfma_f32_16x16x32_bf16 v[20:23], v[132:135], v[12:15], v[20:23]
  v_mfma_f32_16x16x32_bf16 v[24:27], v[136:139], v[12:15], v[24:27]
  v_mfma_f32_16x16x32_bf16 v[28:31], v[140:143], v[12:15], v[28:31]
  v_cndmask_b32 v12, 0, v58, s[40:41]
  v_cndmask_b32 v13, 0, v58, s[42:43]
  v_cndmask_b32 v14, 0, v58, s[44:45]
  v_cndmask_b32 v15, 0, v58, s[46:47]
  s_waitcnt vmcnt(0)
  s_nop 0
  v_mfma_f32_16x16x32_bf16 v[16:19], v[144:147], v[12:15], v[16:19]
  v_mfma_f32_16x16x32_bf16 v[20:23], v[148:151], v[12:15], v[20:23]
  v_mfma_f32_16x16x32_bf16 v[24:27], v[152:155], v[12:15], v[24:27]
  v_mfma_f32_16x16x32_bf16 v[28:31], v[156:159], v[12:15], v[28:31]
  s_nop 4
  ds_write_b32 v6, v16 offset:0
  ds_write_b32 v6, v17 offset:32
  ds_write_b32 v6, v18 offset:64
  ds_write_b32 v6, v19 offset:96
  ds_write_b32 v6, v20 offset:1024
  ds_write_b32 v6, v21 offset:1056
  ds_write_b32 v6, v22 offset:1088
  ds_write_b32 v6, v23 offset:1120
  ds_write_b32 v6, v24 offset:2048
  ds_write_b32 v6, v25 offset:2080
  ds_write_b32 v6, v26 offset:2112
  ds_write_b32 v6, v27 offset:2144
  ds_write_b32 v6, v28 offset:3072
  ds_write_b32 v6, v29 offset:3104
  ds_write_b32 v6, v30 offset:3136
  ds_write_b32 v6, v31 offset:3168
  v_mov_b32 v10, 1
  s_mov_b64 exec, 1
  ds_add_u32 v3, v10 offset:80
  s_mov_b64 exec, -1
  s_mov_b32 s60, 0x200000
L_sp_rd:
  ds_read_b32 v10, v3 offset:80
  s_waitcnt lgkmcnt(0)
  v_readfirstlane_b32 s61, v10
  s_nop 0
  s_cmp_eq_u32 s61, 4
  s_cbranch_scc1 L_sp_rd_d
  s_sub_u32 s60, s60, 1
  s_cmp_lg_u32 s60, 0
  s_cbranch_scc1 L_sp_rd
L_sp_rd_d:
  ds_read_b64 v[16:17], v8 offset:0
  ds_read_b64 v[18:19], v8 offset:2048
  ds_read_b64 v[20:21], v8 offset:20480
  ds_read_b64 v[22:23], v8 offset:22528
  ds_read_b64 v[24:25], v8 offset:40960
  ds_read_b64 v[26:27], v8 offset:43008
  ds_read_b64 v[28:29], v8 offset:61440
  ds_read_b64 v[30:31], v8 offset:63488
  v_mov_b32 v34, s65
  v_mov_b32 v38, s65
  s_waitcnt lgkmcnt(0)
  v_mov_b32 v10, 1
  s_mov_b64 exec, 1
  ds_add_u32 v3, v10 offset:84
  s_mov_b64 exec, -1
  v_pk_add_f32 v[16:17], v[16:17], v[24:25]
  v_pk_add_f32 v[18:19], v[18:19], v[26:27]
  v_pk_add_f32 v[20:21], v[20:21], v[28:29]
  v_pk_add_f32 v[22:23], v[22:23], v[30:31]
  v_pk_add_f32 v[16:17], v[16:17], v[20:21]
  v_pk_add_f32 v[18:19], v[18:19], v[22:23]
  v_mov_b32 v32, v16
  v_mov_b32 v33, v18
  v_mov_b32 v36, v17
  v_mov_b32 v37, v19
  s_cmp_eq_u32 s36, 63
  s_cbranch_scc1 L_sp_nost
  global_store_dwordx4 v9, v[32:35], s[8:9] sc1
  global_store_dwordx4 v9, v[36:39], s[8:9] offset:16 sc1
L_sp_nost:
  s_mov_b32 s60, 0x200000
L_sp_r2:
  ds_read_b32 v10, v3 offset:84
  s_waitcnt lgkmcnt(0)
  v_readfirstlane_b32 s61, v10
  s_nop 0
  s_cmp_eq_u32 s61, 4
  s_cbranch_scc1 L_sp_r2_d
  s_sub_u32 s60, s60, 1
  s_cmp_lg_u32 s60, 0
  s_cbranch_scc1 L_sp_r2
L_sp_r2_d:
  s_branch L_help2
L_help:
  s_cmp_eq_u32 s3, 9
  s_cbranch_scc0 L_help1
  s_getpc_b64 s[20:21]
L_pc_2:
  s_sub_u32 s20, s20, L_pc_2-gated_mix__sliding_block__moe_arch_mod__prompt_kernel
  s_subb_u32 s21, s21, 0
  s_lshr_b32 s22, s2, 3
  s_mul_i32 s22, s22, 1536
  v_lshlrev_b32 v20, 7, v0
  v_add_u32 v20, s22, v20
  v_min_u32 v20, L_end-gated_mix__sliding_block__moe_arch_mod__prompt_kernel, v20
  s_mov_b64 exec, 0xfff
  global_load_dword v21, v20, s[20:21]
  s_mov_b64 exec, -1
L_help1:
  v_mov_b32 v3, 149568
  v_mov_b32 v4, 0
  v_mov_b32 v5, 0
  v_mov_b32 v6, 0
  v_mov_b32 v7, 0
  v_lshlrev_b32 v1, 4, v0
  v_add_u32 v2, v1, v3
  s_mov_b64 exec, 0xff
  ds_write_b128 v2, v[4:7]
  s_mov_b64 exec, -1
  s_waitcnt lgkmcnt(0)
  s_mov_b32 s64, 10371072
  s_load_dword s65, s[8:9], s64
  s_barrier
  s_barrier
  s_waitcnt lgkmcnt(0)
  s_mul_i32 s65, s65, 0x9e3779b1
  s_add_u32 s65, s65, 0x7f4a7c15
L_help2:
  s_and_b32 s31, s2, 7
  s_lshl_b32 s31, s31, 1
  s_bfe_u32 s32, s2, 0x10003
  s_add_u32 s31, s31, s32
  s_lshr_b32 s30, s31, 2
  s_lshr_b32 s32, s2, 4
  s_add_u32 s32, s32, 4
  s_and_b32 s32, s32, 15
  s_lshr_b32 s33, s2, 3
  s_mul_i32 s34, s33, 57
  s_lshr_b32 s34, s34, 9
  s_mul_i32 s53, s34, 9
  s_sub_u32 s53, s33, s53
  s_lshl_b32 s52, s34, 3
  s_and_b32 s34, s2, 7
  s_add_u32 s52, s52, s34
  s_sub_u32 s33, s2, 216
  s_mul_i32 s34, s33, 57
  s_lshr_b32 s34, s34, 9
  s_mul_i32 s35, s34, 9
  s_sub_u32 s33, s33, s35
  s_add_u32 s34, s34, 24
  s_cmp_ge_u32 s2, 216
  s_cselect_b32 s52, s34, s52
  s_cselect_b32 s53, s33, s53
  s_cmp_eq_u32 s3, 8
  s_cbranch_scc1 L_down
  v_lshrrev_b32 v1, 5, v0
  v_bfe_u32 v2, v0, 3, 2
  v_lshrrev_b32 v10, 4, v0
  v_lshlrev_b32 v10, 1, v10
  v_and_b32 v11, 7, v0
  v_xor_b32 v10, v10, v11
  v_lshl_add_u32 v4, v1, 2, v2
  v_mul_u32_u24 v4, 1152, v4
  v_lshl_add_u32 v4, v10, 4, v4
  v_mul_u32_u24 v5, 72, v1
  v_add_u32 v5, v5, v2
  v_mul_u32_u24 v5, 1152, v5
  v_lshl_add_u32 v5, v10, 4, v5
  s_sub_u32 s36, s3, 9
  s_mul_i32 s37, s36, 23040
  s_mul_i32 s43, s36, 165888
  s_lshl_b32 s38, s36, 10
  s_add_u32 s38, s38, 66560
  s_lshl_b32 s39, s53, 7
  s_sub_u32 s42, 663552, s39
  s_add_u32 s16, s28, s39
  s_addc_u32 s17, s29, 0
  s_and_b32 s17, s17, 0xffff
  s_mov_b32 s18, s42
  s_mov_b32 s19, 0x20000
  s_add_u32 s24, s8, 7340032
  s_addc_u32 s25, s9, 0
  s_and_b32 s25, s25, 0xffff
  s_mov_b32 s26, 2359296
  s_mov_b32 s27, 0x20000
  v_mov_b32 v154, 149568
  s_sub_u32 s40, s3, 5
  s_and_b32 s6, s40, 1
  s_lshr_b32 s7, s40, 1
  s_mul_i32 s13, s52, 5
  s_and_b32 s33, s13, 7
  s_sub_u32 s34, 8, s33
  s_cmp_lt_u32 s33, 4
  s_cselect_b32 s34, 0, s34
  s_add_u32 s34, s34, s7
  s_sub_u32 s35, s34, 5
  s_cmp_ge_u32 s34, 5
  s_cselect_b32 s34, s35, s34
  s_add_u32 s13, s13, s34
  s_lshl_b32 s98, s34, 6
  s_mov_b32 s14, 0x404
  s_bitcmp1_b32 s13, 2
  s_mov_b32 s15, 55296
  s_cmp_eq_u32 s7, 1
  s_cselect_b32 s15, 59392, s15
  s_cmp_eq_u32 s7, 2
  s_cselect_b32 s15, 140288, s15
  s_cmp_eq_u32 s7, 3
  s_cselect_b32 s15, 144384, s15
  s_cmp_eq_u32 s7, 4
  s_cselect_b32 s15, 158208, s15
  s_mul_i32 s28, s13, 18432
  s_lshl_b32 s33, s53, 7
  s_add_u32 s29, s28, s33
  s_lshl_b32 s33, s6, 6
  s_add_u32 s29, s29, s33
  s_mul_i32 s33, s6, 9216
  s_add_u32 s28, s28, s33
  s_add_u32 s96, s28, 4096
  s_add_u32 s97, s28, 8192
  v_lshrrev_b32 v140, 2, v0
  v_and_b32 v141, 3, v0
  v_mul_u32_u24 v142, 1152, v140
  v_lshl_add_u32 v142, v141, 4, v142
  v_lshrrev_b32 v146, 2, v0
  v_bfe_u32 v147, v0, 3, 2
  v_lshlrev_b32 v147, 1, v147
  v_bfe_u32 v148, v0, 1, 1
  v_xor_b32 v147, v147, v148
  v_and_b32 v148, 1, v0
  v_lshlrev_b32 v148, 3, v148
  v_lshl_add_u32 v148, v146, 7, v148
  v_lshl_add_u32 v148, v147, 4, v148
  s_mul_i32 s33, s6, 36864
  s_add_u32 s33, s33, 66560
  s_lshl_b32 s34, s6, 6
  v_xor_b32 v148, s34, v148
  v_xor_b32 v156, 0, v148
  v_add_u32 v156, s33, v156
  v_xor_b32 v157, 32, v148
  v_add_u32 v157, s33, v157
  v_xor_b32 v158, 64, v148
  v_add_u32 v158, s33, v158
  v_xor_b32 v159, 96, v148
  v_add_u32 v159, s33, v159
  v_lshlrev_b32 v162, 4, v0
  s_lshl_b32 s33, s6, 11
  s_add_u32 s15, s15, s33
  v_add_u32 v160, s15, v162
  s_lshl_b32 s33, s33, 1
  s_sub_u32 s33, 2048, s33
  v_add_u32 v164, s33, v160
  s_lshl_b32 s33, s7, 1
  s_add_u32 s33, s33, s6
  s_lshl_b32 s33, s33, 2
  s_add_u32 s33, s33, 149568
  v_mov_b32 v161, s33
  v_xor_b32 v165, 4, v161
  v_and_b32 v143, 15, v0
  v_mul_u32_u24 v143, 80, v143
  v_lshrrev_b32 v146, 4, v0
  v_lshlrev_b32 v146, 3, v146
  v_add3_u32 v143, v143, v146, s15
  v_mul_u32_u24 v144, 80, v140
  v_lshl_add_u32 v144, v141, 4, v144
  v_add_u32 v144, s15, v144
  s_add_u32 s98, s98, 154624
  v_lshl_add_u32 v145, v140, 2, s98
  s_cmp_lt_u32 s3, 4
  s_cselect_b32 s33, 1, 0x100
  v_mov_b32 v163, s33
  s_setprio 3
  s_cmp_ge_u32 s2, 192
  s_cbranch_scc1 L_wo_go
  s_barrier
  s_barrier
  s_barrier
  s_barrier
  s_barrier
  s_barrier
  s_barrier
  s_barrier
  s_barrier
L_wo_go:
  s_cmp_eq_u32 s3, 11
  s_cbranch_scc1 L_ctl
  s_cmp_ge_u32 s52, 26
  s_cbranch_scc1 L_end
  s_mov_b32 s60, 0x200000
L_wo_w:
  ds_read_b32 v10, v3 offset:8
  s_waitcnt lgkmcnt(0)
  v_readfirstlane_b32 s61, v10
  s_nop 0
  s_bitcmp1_b32 s61, 3
  s_cbranch_scc1 L_wo_w_d
  s_sleep 2
  s_sub_u32 s60, s60, 1
  s_cmp_lg_u32 s60, 0
  s_cbranch_scc1 L_wo_w
L_wo_w_d:
  s_add_u32 m0, s38, 0
  s_add_u32 s40, s37, 0
  buffer_load_dwordx4 v4, s[16:19], s40 offen lds
  s_add_u32 m0, s38, 2048
  s_add_u32 s40, s37, 9216
  buffer_load_dwordx4 v4, s[16:19], s40 offen lds
  s_add_u32 m0, s38, 4096
  s_add_u32 s40, s37, 41472
  buffer_load_dwordx4 v4, s[16:19], s40 offen lds
  s_add_u32 m0, s38, 6144
  s_add_u32 s40, s37, 50688
  buffer_load_dwordx4 v4, s[16:19], s40 offen lds
  s_add_u32 m0, s38, 8192
  s_add_u32 s40, s37, 82944
  buffer_load_dwordx4 v4, s[16:19], s40 offen lds
  s_add_u32 m0, s38, 10240
  s_add_u32 s40, s37, 92160
  buffer_load_dwordx4 v4, s[16:19], s40 offen lds
  s_add_u32 m0, s38, 12288
  s_add_u32 s40, s37, 124416
  buffer_load_dwordx4 v4, s[16:19], s40 offen lds
  s_add_u32 m0, s38, 14336
  s_add_u32 s40, s37, 133632
  buffer_load_dwordx4 v4, s[16:19], s40 offen lds
  s_add_u32 m0, s38, 16384
  s_add_u32 s40, s37, 165888
  buffer_load_dwordx4 v4, s[16:19], s40 offen lds
  s_add_u32 m0, s38, 18432
  s_add_u32 s40, s37, 175104
  buffer_load_dwordx4 v4, s[16:19], s40 offen lds
  s_add_u32 m0, s38, 20480
  s_add_u32 s40, s37, 207360
  buffer_load_dwordx4 v4, s[16:19], s40 offen lds
  s_add_u32 m0, s38, 22528
  s_add_u32 s40, s37, 216576
  buffer_load_dwordx4 v4, s[16:19], s40 offen lds
  s_waitcnt vmcnt(11)
  s_add_u32 m0, s38, 24576
  s_add_u32 s40, s37, 248832
  buffer_load_dwordx4 v4, s[16:19], s40 offen lds
  s_waitcnt vmcnt(11)
  s_add_u32 m0, s38, 26624
  s_add_u32 s40, s37, 258048
  buffer_load_dwordx4 v4, s[16:19], s40 offen lds
  s_waitcnt vmcnt(11)
  s_add_u32 m0, s38, 28672
  s_add_u32 s40, s37, 290304
  buffer_load_dwordx4 v4, s[16:19], s40 offen lds
  s_waitcnt vmcnt(11)
  s_add_u32 m0, s38, 30720
  s_add_u32 s40, s37, 299520
  buffer_load_dwordx4 v4, s[16:19], s40 offen lds
  s_waitcnt vmcnt(11)
  s_add_u32 m0, s38, 32768
  s_add_u32 s40, s37, 331776
  buffer_load_dwordx4 v4, s[16:19], s40 offen lds
  s_waitcnt vmcnt(11)
  s_add_u32 m0, s38, 34816
  s_add_u32 s40, s37, 340992
  buffer_load_dwordx4 v4, s[16:19], s40 offen lds
  s_waitcnt vmcnt(11)
  s_add_u32 m0, s38, 36864
  s_add_u32 s40, s37, 373248
  buffer_load_dwordx4 v4, s[16:19], s40 offen lds
  s_waitcnt vmcnt(11)
  s_add_u32 m0, s38, 38912
  s_add_u32 s40, s37, 382464
  buffer_load_dwordx4 v4, s[16:19], s40 offen lds
  s_waitcnt vmcnt(11)
  s_add_u32 m0, s38, 40960
  s_add_u32 s40, s37, 414720
  buffer_load_dwordx4 v4, s[16:19], s40 offen lds
  s_waitcnt vmcnt(11)
  s_add_u32 m0, s38, 43008
  s_add_u32 s40, s37, 423936
  buffer_load_dwordx4 v4, s[16:19], s40 offen lds
  s_waitcnt vmcnt(11)
  s_add_u32 m0, s38, 45056
  s_add_u32 s40, s37, 456192
  buffer_load_dwordx4 v4, s[16:19], s40 offen lds
  s_waitcnt vmcnt(11)
  s_add_u32 m0, s38, 47104
  s_add_u32 s40, s37, 465408
  buffer_load_dwordx4 v4, s[16:19], s40 offen lds
  s_waitcnt vmcnt(11)
  s_add_u32 m0, s38, 49152
  s_add_u32 s40, s37, 497664
  buffer_load_dwordx4 v4, s[16:19], s40 offen lds
  s_waitcnt vmcnt(11)
  s_add_u32 m0, s38, 51200
  s_add_u32 s40, s37, 506880
  buffer_load_dwordx4 v4, s[16:19], s40 offen lds
  s_waitcnt vmcnt(11)
  s_add_u32 m0, s38, 53248
  s_add_u32 s40, s37, 539136
  buffer_load_dwordx4 v4, s[16:19], s40 offen lds
  s_waitcnt vmcnt(11)
  s_add_u32 m0, s38, 55296
  s_add_u32 s40, s37, 548352
  buffer_load_dwordx4 v4, s[16:19], s40 offen lds
  s_waitcnt vmcnt(11)
  s_add_u32 m0, s38, 57344
  s_add_u32 s40, s37, 580608
  buffer_load_dwordx4 v4, s[16:19], s40 offen lds
  s_waitcnt vmcnt(11)
  s_add_u32 m0, s38, 59392
  s_add_u32 s40, s37, 589824
  buffer_load_dwordx4 v4, s[16:19], s40 offen lds
  s_waitcnt vmcnt(11)
  s_add_u32 m0, s38, 61440
  s_add_u32 s40, s37, 622080
  buffer_load_dwordx4 v4, s[16:19], s40 offen lds
  s_waitcnt vmcnt(11)
  s_add_u32 m0, s38, 63488
  s_add_u32 s40, s37, 631296
  buffer_load_dwordx4 v4, s[16:19], s40 offen lds
  s_waitcnt vmcnt(11)
  s_add_u32 m0, s38, 65536
  s_add_u32 s40, s43, 18432
  buffer_load_dwordx4 v5, s[16:19], s40 offen lds
  s_waitcnt vmcnt(11)
  s_add_u32 m0, s38, 67584
  s_add_u32 s40, s43, 59904
  buffer_load_dwordx4 v5, s[16:19], s40 offen lds
  s_waitcnt vmcnt(11)
  s_add_u32 m0, s38, 69632
  s_add_u32 s40, s43, 350208
  buffer_load_dwordx4 v5, s[16:19], s40 offen lds
  s_waitcnt vmcnt(11)
  s_add_u32 m0, s38, 71680
  s_add_u32 s40, s43, 391680
  buffer_load_dwordx4 v5, s[16:19], s40 offen lds
  s_waitcnt vmcnt(11)
  s_mov_b32 s20, s4
  s_and_b32 s21, s5, 0xffff
  s_mov_b32 s22, 2359296
  s_mov_b32 s23, 0x20000
  buffer_load_dwordx4 v[128:131], v142, s[20:23], s29 offen
  s_waitcnt vmcnt(1)
  v_mov_b32 v4, 1
  s_mov_b64 exec, 1
  ds_add_u32 v3, v4 offset:12
  s_mov_b64 exec, -1
  s_setprio 0
  s_branch L_out
L_ctl:
  v_lshlrev_b32 v8, 7, v0
  v_add_u32 v9, 10280960, v8
  s_mul_i32 s46, s52, 5
  s_lshr_b32 s46, s46, 3
  s_min_u32 s46, s46, 14
  s_lshl_b32 s46, s46, 11
  s_add_u32 s46, s46, 10248192
  v_add_u32 v8, s46, v8
  s_lshl_b32 s46, s32, 4
  s_add_u32 s46, s46, s31
  s_lshl_b32 s46, s46, 7
  s_add_u32 s46, s46, 10248192
  v_mov_b32 v14, s46
  v_mov_b32 v15, s65
  s_cmp_ge_u32 s2, 192
  s_cbranch_scc1 L_ct_0
  v_add_u32 v16, 2, v0
  v_mul_u32_u24 v17, 43, v16
  v_lshrrev_b32 v17, 7, v17
  v_mul_u32_u24 v18, 3, v17
  v_sub_u32 v16, v16, v18
  s_sub_u32 s35, s32, 2
  v_add_u32 v16, s35, v16
  v_max_i32 v16, 0, v16
  v_mul_u32_u24 v16, 12, v16
  v_lshl_add_u32 v16, v17, 2, v16
  v_add_u32 v16, s30, v16
  v_lshlrev_b32 v16, 7, v16
  v_add_u32 v16, 10223616, v16
  s_mov_b32 s60, 0x200000
L_qp1w:
  ds_read_b32 v18, v3 offset:40
  s_waitcnt lgkmcnt(0)
  v_readfirstlane_b32 s61, v18
  s_nop 0
  s_cmp_eq_u32 s61, 8
  s_cbranch_scc1 L_qp1w_d
  s_sub_u32 s60, s60, 1
  s_cmp_lg_u32 s60, 0
  s_cbranch_scc1 L_qp1w
L_qp1w_d:
  s_mov_b64 exec, 0x7f
  s_mov_b32 s60, 0x40000
L_qp1:
  global_load_dword v17, v16, s[8:9] sc1
  s_waitcnt vmcnt(0)
  v_cmp_eq_u32 vcc, s65, v17
  s_nop 0
  s_cmp_eq_u64 vcc, exec
  s_cbranch_scc1 L_qp1_d
  s_sub_u32 s60, s60, 1
  s_cmp_lg_u32 s60, 0
  s_cbranch_scc1 L_qp1
L_qp1_d:
  s_mov_b64 exec, -1
  v_mov_b32 v18, 1
  s_mov_b64 exec, 1
  ds_add_u32 v3, v18 offset:44
  s_mov_b64 exec, -1
L_ct_0:
  v_bfe_u32 v20, v0, 4, 1
  v_mul_u32_u24 v20, 18432, v20
  v_and_b32 v21, 15, v0
  v_lshl_add_u32 v20, v21, 4, v20
  v_lshrrev_b32 v21, 5, v0
  v_lshl_add_u32 v22, v21, 2, v20
  v_lshl_add_u32 v21, v21, 8, v20
  v_mov_b32 v24, -1
  v_mov_b32 v25, -1
  v_mov_b32 v26, -1
  v_mov_b32 v27, -1
  s_mul_i32 s54, s32, 147456
  s_lshl_b32 s55, s31, 10
  s_add_u32 s55, s55, s54
  s_lshr_b32 s56, s31, 1
  s_lshl_b32 s56, s56, 8
  s_and_b32 s57, s31, 1
  s_lshl_b32 s57, s57, 3
  s_add_u32 s56, s56, s57
  s_add_u32 s56, s56, s54
  s_add_u32 s56, s56, 16384
  s_mov_b32 s60, 0x200000
L_ct_p:
  ds_read_b32 v10, v3 offset:8
  s_waitcnt lgkmcnt(0)
  v_readfirstlane_b32 s61, v10
  s_nop 0
  s_bitcmp1_b32 s61, 3
  s_cbranch_scc1 L_ct_p_d
  s_sub_u32 s60, s60, 1
  s_cmp_lg_u32 s60, 0
  s_cbranch_scc1 L_ct_p
L_ct_p_d:
  buffer_store_dword v24, v22, s[24:27], s56 offen sc1
  buffer_store_dwordx4 v[24:27], v21, s[24:27], s55 offen sc1
  buffer_store_dwordx4 v[24:27], v21, s[24:27], s55 offen offset:512 sc1
  s_add_u32 s55, s55, 36864
  s_add_u32 s56, s56, 36864
  buffer_store_dword v24, v22, s[24:27], s56 offen sc1
  buffer_store_dwordx4 v[24:27], v21, s[24:27], s55 offen sc1
  buffer_store_dwordx4 v[24:27], v21, s[24:27], s55 offen offset:512 sc1
  s_add_u32 s55, s55, 36864
  s_add_u32 s56, s56, 36864
  buffer_store_dword v24, v22, s[24:27], s56 offen sc1
  buffer_store_dwordx4 v[24:27], v21, s[24:27], s55 offen sc1
  buffer_store_dwordx4 v[24:27], v21, s[24:27], s55 offen offset:512 sc1
  s_add_u32 s55, s55, 36864
  s_add_u32 s56, s56, 36864
  buffer_store_dword v24, v22, s[24:27], s56 offen sc1
  buffer_store_dwordx4 v[24:27], v21, s[24:27], s55 offen sc1
  buffer_store_dwordx4 v[24:27], v21, s[24:27], s55 offen offset:512 sc1
  s_add_u32 s55, s55, 36864
  s_add_u32 s56, s56, 36864
  v_mov_b32 v4, 1
  s_waitcnt vmcnt(0)
  ds_write_b32 v3, v4 offset:48
  s_mov_b64 exec, 1
  global_store_dword v14, v15, s[8:9] sc1
  s_mov_b64 exec, -1
  s_mov_b32 s60, 0x200000
L_ct_q:
  ds_read_b32 v10, v3 offset:36
  s_waitcnt lgkmcnt(0)
  v_readfirstlane_b32 s61, v10
  s_nop 0
  s_cmp_eq_u32 s61, 8
  s_cbranch_scc1 L_ct_q_d
  s_sleep 1
  s_sub_u32 s60, s60, 1
  s_cmp_lg_u32 s60, 0
  s_cbranch_scc1 L_ct_q
L_ct_q_d:
  s_mov_b64 exec, -1
  s_mov_b32 s60, 0x40000
L_pap:
  global_load_dwordx3 v[4:6], v9, s[8:9] sc1
  s_waitcnt vmcnt(0)
  v_cmp_eq_u32 vcc, s65, v4
  s_nop 0
  s_cmp_eq_u64 vcc, exec
  s_cbranch_scc1 L_pap_d
  s_sleep 8
  s_sub_u32 s60, s60, 1
  s_cmp_lg_u32 s60, 0
  s_cbranch_scc1 L_pap
L_pap_d:
  s_mov_b64 exec, -1
  v_mov_b32 v10, v5
  v_mov_b32 v11, v6
  v_mov_b32 v4, 1
  ds_write_b64 v3, v[10:11] offset:56
  ds_write_b32 v3, v4 offset:52
  s_add_u32 s16, s8, 9977856
  s_addc_u32 s17, s9, 0
  s_and_b32 s17, s17, 0xffff
  s_mov_b32 s18, 8192
  s_mov_b32 s19, 0x20000
  s_mul_i32 s40, s52, 320
  v_lshlrev_b32 v4, 2, v0
  buffer_load_dword v5, v4, s[16:19], s40 offen sc1
  buffer_load_dword v6, v4, s[16:19], s40 offen offset:256 sc1
  v_add_u32 v4, 154624, v4
  s_mov_b64 exec, 0xffffffff
  s_mov_b32 s60, 0x40000
L_op:
  global_load_dword v12, v8, s[8:9] sc1
  s_waitcnt vmcnt(0)
  v_cmp_eq_u32 vcc, s65, v12
  s_nop 0
  s_cmp_eq_u64 vcc, exec
  s_cbranch_scc1 L_op_d
  s_sleep 2
  s_sub_u32 s60, s60, 1
  s_cmp_lg_u32 s60, 0
  s_cbranch_scc1 L_op
L_op_d:
  s_mov_b64 exec, -1
  ds_write_b32 v4, v5
  ds_write_b32 v4, v6 offset:256
  v_mov_b32 v10, 1
  s_mov_b64 exec, 1
  ds_add_u32 v3, v10 offset:4
  s_mov_b64 exec, -1
  ds_read_b64 v[10:11], v3 offset:56
  s_waitcnt lgkmcnt(0)
  v_readfirstlane_b32 s12, v10
  v_readfirstlane_b32 s13, v11
  s_mul_i32 s46, s52, 80
  s_sub_u32 s46, s12, s46
  s_cmp_lt_u32 s46, 80
  s_cbranch_scc0 L_end
  v_lshlrev_b32 v4, 7, v0
  v_add_u32 v4, 10289152, v4
  s_add_u32 s16, s8, 10092544
  s_addc_u32 s17, s9, 0
  s_and_b32 s17, s17, 0xffff
  s_mov_b32 s18, 36864
  s_mov_b32 s19, 0x20000
  v_lshrrev_b32 v6, 4, v0
  v_mul_u32_u24 v6, 2304, v6
  v_and_b32 v7, 15, v0
  v_lshlrev_b32 v7, 4, v7
  v_add_u32 v6, v6, v7
  v_add_u32 v7, 149696, v7
  s_lshl_b32 s40, s53, 8
  s_mov_b64 exec, 0xffff
  s_mov_b32 s60, 0x40000
L_yp:
  global_load_dword v5, v4, s[8:9] sc1
  s_waitcnt vmcnt(0)
  v_cmp_eq_u32 vcc, 12, v5
  s_nop 0
  s_cmp_eq_u64 vcc, exec
  s_cbranch_scc1 L_yp_d
  s_sleep 2
  s_sub_u32 s60, s60, 1
  s_cmp_lg_u32 s60, 0
  s_cbranch_scc1 L_yp
L_yp_d:
  s_mov_b64 exec, -1
  buffer_load_dwordx4 v[8:11], v6, s[16:19], s40 offen sc1
  s_add_u32 s40, s40, 9216
  buffer_load_dwordx4 v[12:15], v6, s[16:19], s40 offen sc1
  s_add_u32 s40, s40, 9216
  buffer_load_dwordx4 v[16:19], v6, s[16:19], s40 offen sc1
  s_add_u32 s40, s40, 9216
  buffer_load_dwordx4 v[20:23], v6, s[16:19], s40 offen sc1
  s_add_u32 s40, s40, 9216
  s_waitcnt vmcnt(0)
  v_pk_add_f32 v[8:9], v[8:9], v[12:13]
  v_pk_add_f32 v[10:11], v[10:11], v[14:15]
  v_pk_add_f32 v[8:9], v[8:9], v[16:17]
  v_pk_add_f32 v[10:11], v[10:11], v[18:19]
  v_pk_add_f32 v[8:9], v[8:9], v[20:21]
  v_pk_add_f32 v[10:11], v[10:11], v[22:23]
  v_mov_b32 v20, v8
  s_nop 1
  v_permlane32_swap_b32 v20, v8
  v_add_f32 v8, v8, v20
  v_mov_b32 v20, v8
  s_nop 1
  v_permlane16_swap_b32 v20, v8
  v_add_f32 v8, v8, v20
  v_cvt_pk_bf16_f32 v8, v8, v8
  v_lshlrev_b32 v8, 16, v8
  v_mul_f32 v8, s13, v8
  v_cvt_pk_bf16_f32 v8, v8, v8
  v_lshlrev_b32 v8, 16, v8
  v_mov_b32 v20, v9
  s_nop 1
  v_permlane32_swap_b32 v20, v9
  v_add_f32 v9, v9, v20
  v_mov_b32 v20, v9
  s_nop 1
  v_permlane16_swap_b32 v20, v9
  v_add_f32 v9, v9, v20
  v_cvt_pk_bf16_f32 v9, v9, v9
  v_lshlrev_b32 v9, 16, v9
  v_mul_f32 v9, s13, v9
  v_cvt_pk_bf16_f32 v9, v9, v9
  v_lshlrev_b32 v9, 16, v9
  v_mov_b32 v20, v10
  s_nop 1
  v_permlane32_swap_b32 v20, v10
  v_add_f32 v10, v10, v20
  v_mov_b32 v20, v10
  s_nop 1
  v_permlane16_swap_b32 v20, v10
  v_add_f32 v10, v10, v20
  v_cvt_pk_bf16_f32 v10, v10, v10
  v_lshlrev_b32 v10, 16, v10
  v_mul_f32 v10, s13, v10
  v_cvt_pk_bf16_f32 v10, v10, v10
  v_lshlrev_b32 v10, 16, v10
  v_mov_b32 v20, v11
  s_nop 1
  v_permlane32_swap_b32 v20, v11
  v_add_f32 v11, v11, v20
  v_mov_b32 v20, v11
  s_nop 1
  v_permlane16_swap_b32 v20, v11
  v_add_f32 v11, v11, v20
  v_cvt_pk_bf16_f32 v11, v11, v11
  v_lshlrev_b32 v11, 16, v11
  v_mul_f32 v11, s13, v11
  v_cvt_pk_bf16_f32 v11, v11, v11
  v_lshlrev_b32 v11, 16, v11
  v_mov_b32 v12, 1
  ds_write_b128 v7, v[8:11]
  ds_write_b32 v3, v12 offset:32
  s_cmp_eq_u32 s53, 0
  s_cbranch_scc0 L_end
  v_mov_b32 v4, 10371072
  v_mov_b32 v5, s65
  s_mov_b64 exec, 1
  global_store_dword v4, v5, s[8:9]
  s_endpgm
L_down:
  s_cmp_ge_u32 s2, 192
  s_cbranch_scc1 L_end
  v_lshrrev_b32 v2, 3, v0
  v_and_b32 v10, 7, v0
  v_mul_u32_u24 v16, 1152, v2
  v_lshl_add_u32 v16, v10, 4, v16
  s_mul_i32 s36, s2, 24
  v_mul_u32_u24 v12, 73728, v10
  v_add_u32 v11, s36, v2
  v_lshl_add_u32 v17, v11, 4, v12
  v_cmp_gt_u32 s[56:57], 7, v10
  s_mul_i32 s37, s2, 27648
  v_and_b32 v1, 1, v0
  v_lshlrev_b32 v1, 4, v1
  v_bfe_u32 v11, v0, 1, 2
  v_cmp_eq_u32 s[44:45], 0, v11
  v_cmp_eq_u32 s[46:47], 1, v11
  v_cmp_eq_u32 s[48:49], 2, v11
  v_cmp_eq_u32 s[50:51], 3, v11
  v_lshrrev_b32 v11, 5, v0
  v_bfe_u32 v12, v0, 3, 1
  v_cmp_eq_u32 s[52:53], v11, v12
  v_mul_u32_u24 v12, 2304, v12
  v_bfe_u32 v11, v0, 4, 1
  v_lshl_add_u32 v12, v11, 4, v12
  v_lshl_add_u32 v12, v10, 5, v12
  v_add_u32 v164, 150016, v12
  v_lshlrev_b32 v165, 2, v0
  v_lshl_add_u32 v166, v10, 3, v2
  v_lshlrev_b32 v166, 2, v166
  v_add_u32 v166, 150016, v166
  v_cmp_eq_u32 s[58:59], 1, v10
  v_cmp_eq_u32 s[54:55], 2, v10
  s_and_b32 s38, s2, 15
  s_mul_i32 s39, s38, 2304
  s_add_u32 s39, s39, 10092544
  v_add_u32 v165, s39, v165
  s_lshl_b32 s38, s38, 7
  s_add_u32 s38, s38, 10289152
  s_add_u32 s16, s14, s37
  s_addc_u32 s17, s15, 0
  s_and_b32 s17, s17, 0xffff
  s_mov_b32 s18, 27648
  s_mov_b32 s19, 0x20000
  s_add_u32 s20, s8, 11534336
  s_addc_u32 s21, s9, 0
  s_and_b32 s21, s21, 0xffff
  s_mov_b32 s22, 516096
  s_mov_b32 s23, 0x20000
  s_barrier
  s_barrier
  s_barrier
  s_barrier
  s_barrier
  s_barrier
  s_barrier
  s_movk_i32 s40, 0
  buffer_load_dwordx4 v[20:23], v16, s[16:19], s40 offen offset:0 nt
  buffer_load_dwordx4 v[24:27], v16, s[16:19], s40 offen offset:128 nt
  buffer_load_dwordx4 v[28:31], v16, s[16:19], s40 offen offset:256 nt
  buffer_load_dwordx4 v[32:35], v16, s[16:19], s40 offen offset:384 nt
  buffer_load_dwordx4 v[36:39], v16, s[16:19], s40 offen offset:512 nt
  buffer_load_dwordx4 v[40:43], v16, s[16:19], s40 offen offset:640 nt
  buffer_load_dwordx4 v[44:47], v16, s[16:19], s40 offen offset:768 nt
  buffer_load_dwordx4 v[48:51], v16, s[16:19], s40 offen offset:896 nt
  buffer_load_dwordx4 v[52:55], v16, s[16:19], s40 offen offset:1024 nt
  s_movk_i32 s40, 9216
  buffer_load_dwordx4 v[56:59], v16, s[16:19], s40 offen offset:0 nt
  buffer_load_dwordx4 v[60:63], v16, s[16:19], s40 offen offset:128 nt
  buffer_load_dwordx4 v[64:67], v16, s[16:19], s40 offen offset:256 nt
  buffer_load_dwordx4 v[68:71], v16, s[16:19], s40 offen offset:384 nt
  buffer_load_dwordx4 v[72:75], v16, s[16:19], s40 offen offset:512 nt
  buffer_load_dwordx4 v[76:79], v16, s[16:19], s40 offen offset:640 nt
  buffer_load_dwordx4 v[80:83], v16, s[16:19], s40 offen offset:768 nt
  buffer_load_dwordx4 v[84:87], v16, s[16:19], s40 offen offset:896 nt
  buffer_load_dwordx4 v[88:91], v16, s[16:19], s40 offen offset:1024 nt
  s_movk_i32 s40, 18432
  buffer_load_dwordx4 v[92:95], v16, s[16:19], s40 offen offset:0 nt
  buffer_load_dwordx4 v[96:99], v16, s[16:19], s40 offen offset:128 nt
  buffer_load_dwordx4 v[100:103], v16, s[16:19], s40 offen offset:256 nt
  buffer_load_dwordx4 v[104:107], v16, s[16:19], s40 offen offset:384 nt
  buffer_load_dwordx4 v[108:111], v16, s[16:19], s40 offen offset:512 nt
  buffer_load_dwordx4 v[112:115], v16, s[16:19], s40 offen offset:640 nt
  buffer_load_dwordx4 v[116:119], v16, s[16:19], s40 offen offset:768 nt
  buffer_load_dwordx4 v[120:123], v16, s[16:19], s40 offen offset:896 nt
  buffer_load_dwordx4 v[124:127], v16, s[16:19], s40 offen offset:1024 nt
  s_barrier
  s_barrier
  s_mov_b32 s60, 0x200000
L_dn_w2:
  ds_read_b32 v10, v3 offset:40
  s_waitcnt lgkmcnt(0)
  v_readfirstlane_b32 s61, v10
  s_nop 0
  s_cmp_eq_u32 s61, 8
  s_cbranch_scc1 L_dn_w2_d
  s_sleep 2
  s_sub_u32 s60, s60, 1
  s_cmp_lg_u32 s60, 0
  s_cbranch_scc1 L_dn_w2
L_dn_w2_d:
  s_setprio 2
  s_mov_b32 s60, 0x40000
L_dn_pa:
  buffer_load_dwordx3 v[4:6], v17, s[20:23], 0 offen sc1
  buffer_load_dwordx3 v[8:10], v17, s[20:23], 0 offen offset:128 sc1
  buffer_load_dwordx3 v[160:162], v17, s[20:23], 0 offen offset:256 sc1
  s_waitcnt vmcnt(0)
  v_cmp_ne_u32 vcc, s65, v6
  v_cmp_ne_u32 s[40:41], s65, v10
  v_cmp_ne_u32 s[42:43], s65, v162
  s_or_b64 vcc, vcc, s[40:41]
  s_or_b64 vcc, vcc, s[42:43]
  s_and_b64 vcc, vcc, s[56:57]
  s_cmp_eq_u64 vcc, 0
  s_cbranch_scc1 L_dn_pb
  s_sleep 8
  s_sub_u32 s60, s60, 1
  s_cbranch_scc0 L_dn_pa
L_dn_pb:
  v_mov_b32 v6, v8
  v_mov_b32 v7, v9
  v_mov_b32 v8, v160
  v_mov_b32 v9, v161
  v_add_f32_dpp v4, v4, v4 quad_perm:[1,0,3,2] row_mask:0xf bank_mask:0xf
  v_add_f32_dpp v5, v5, v5 quad_perm:[1,0,3,2] row_mask:0xf bank_mask:0xf
  v_add_f32_dpp v6, v6, v6 quad_perm:[1,0,3,2] row_mask:0xf bank_mask:0xf
  v_add_f32_dpp v7, v7, v7 quad_perm:[1,0,3,2] row_mask:0xf bank_mask:0xf
  v_add_f32_dpp v8, v8, v8 quad_perm:[1,0,3,2] row_mask:0xf bank_mask:0xf
  v_add_f32_dpp v9, v9, v9 quad_perm:[1,0,3,2] row_mask:0xf bank_mask:0xf
  v_add_f32_dpp v4, v4, v4 quad_perm:[2,3,0,1] row_mask:0xf bank_mask:0xf
  v_add_f32_dpp v5, v5, v5 quad_perm:[2,3,0,1] row_mask:0xf bank_mask:0xf
  v_add_f32_dpp v6, v6, v6 quad_perm:[2,3,0,1] row_mask:0xf bank_mask:0xf
  v_add_f32_dpp v7, v7, v7 quad_perm:[2,3,0,1] row_mask:0xf bank_mask:0xf
  v_add_f32_dpp v8, v8, v8 quad_perm:[2,3,0,1] row_mask:0xf bank_mask:0xf
  v_add_f32_dpp v9, v9, v9 quad_perm:[2,3,0,1] row_mask:0xf bank_mask:0xf
  v_add_f32_dpp v4, v4, v4 row_half_mirror row_mask:0xf bank_mask:0xf
  v_add_f32_dpp v5, v5, v5 row_half_mirror row_mask:0xf bank_mask:0xf
  v_add_f32_dpp v6, v6, v6 row_half_mirror row_mask:0xf bank_mask:0xf
  v_add_f32_dpp v7, v7, v7 row_half_mirror row_mask:0xf bank_mask:0xf
  v_add_f32_dpp v8, v8, v8 row_half_mirror row_mask:0xf bank_mask:0xf
  v_add_f32_dpp v9, v9, v9 row_half_mirror row_mask:0xf bank_mask:0xf
  v_cndmask_b32 v4, v4, v6, s[58:59]
  v_cndmask_b32 v5, v5, v7, s[58:59]
  v_cndmask_b32 v4, v4, v8, s[54:55]
  v_cndmask_b32 v5, v5, v9, s[54:55]
  v_cvt_pk_bf16_f32 v4, v4, v4
  v_lshlrev_b32 v4, 16, v4
  v_cvt_pk_bf16_f32 v5, v5, v5
  v_lshlrev_b32 v5, 16, v5
  v_mul_f32 v10, 0xbfb8aa3b, v4
  v_exp_f32 v10, v10
  s_nop 0
  v_add_f32 v10, 1.0, v10
  v_rcp_f32 v10, v10
  s_nop 0
  v_mul_f32 v4, v4, v10
  v_cvt_pk_bf16_f32 v4, v4, v4
  v_lshlrev_b32 v4, 16, v4
  v_mul_f32 v4, v4, v5
  v_cvt_pk_bf16_f32 v4, v4, v4
  v_and_b32 v4, 0xffff, v4
  s_nop 1
  v_mov_b32_dpp v4, v4 row_shr:4 row_mask:0xf bank_mask:0xa
  s_nop 1
  v_mov_b32_dpp v6, v4 quad_perm:[0,0,0,0] row_mask:0xf bank_mask:0xf
  v_mov_b32_dpp v7, v4 quad_perm:[1,1,1,1] row_mask:0xf bank_mask:0xf
  v_mov_b32_dpp v8, v4 quad_perm:[2,2,2,2] row_mask:0xf bank_mask:0xf
  v_lshlrev_b32 v6, v1, v6
  v_lshlrev_b32 v7, v1, v7
  v_lshlrev_b32 v8, v1, v8
  v_cndmask_b32 v12, 0, v6, s[44:45]
  v_cndmask_b32 v13, 0, v6, s[46:47]
  v_cndmask_b32 v14, 0, v6, s[48:49]
  v_cndmask_b32 v15, 0, v6, s[50:51]
  s_nop 1
  v_mfma_f32_16x16x32_bf16 v[128:131], v[20:23], v[12:15], 0
  v_mfma_f32_16x16x32_bf16 v[132:135], v[24:27], v[12:15], 0
  v_mfma_f32_16x16x32_bf16 v[136:139], v[28:31], v[12:15], 0
  v_mfma_f32_16x16x32_bf16 v[140:143], v[32:35], v[12:15], 0
  v_mfma_f32_16x16x32_bf16 v[144:147], v[36:39], v[12:15], 0
  v_mfma_f32_16x16x32_bf16 v[148:151], v[40:43], v[12:15], 0
  v_mfma_f32_16x16x32_bf16 v[152:155], v[44:47], v[12:15], 0
  v_mfma_f32_16x16x32_bf16 v[156:159], v[48:51], v[12:15], 0
  v_mfma_f32_16x16x32_bf16 v[160:163], v[52:55], v[12:15], 0
  v_cndmask_b32 v12, 0, v7, s[44:45]
  v_cndmask_b32 v13, 0, v7, s[46:47]
  v_cndmask_b32 v14, 0, v7, s[48:49]
  v_cndmask_b32 v15, 0, v7, s[50:51]
  s_nop 1
  v_mfma_f32_16x16x32_bf16 v[128:131], v[56:59], v[12:15], v[128:131]
  v_mfma_f32_16x16x32_bf16 v[132:135], v[60:63], v[12:15], v[132:135]
  v_mfma_f32_16x16x32_bf16 v[136:139], v[64:67], v[12:15], v[136:139]
  v_mfma_f32_16x16x32_bf16 v[140:143], v[68:71], v[12:15], v[140:143]
  v_mfma_f32_16x16x32_bf16 v[144:147], v[72:75], v[12:15], v[144:147]
  v_mfma_f32_16x16x32_bf16 v[148:151], v[76:79], v[12:15], v[148:151]
  v_mfma_f32_16x16x32_bf16 v[152:155], v[80:83], v[12:15], v[152:155]
  v_mfma_f32_16x16x32_bf16 v[156:159], v[84:87], v[12:15], v[156:159]
  v_mfma_f32_16x16x32_bf16 v[160:163], v[88:91], v[12:15], v[160:163]
  v_cndmask_b32 v12, 0, v8, s[44:45]
  v_cndmask_b32 v13, 0, v8, s[46:47]
  v_cndmask_b32 v14, 0, v8, s[48:49]
  v_cndmask_b32 v15, 0, v8, s[50:51]
  s_nop 1
  v_mfma_f32_16x16x32_bf16 v[128:131], v[92:95], v[12:15], v[128:131]
  v_mfma_f32_16x16x32_bf16 v[132:135], v[96:99], v[12:15], v[132:135]
  v_mfma_f32_16x16x32_bf16 v[136:139], v[100:103], v[12:15], v[136:139]
  v_mfma_f32_16x16x32_bf16 v[140:143], v[104:107], v[12:15], v[140:143]
  v_mfma_f32_16x16x32_bf16 v[144:147], v[108:111], v[12:15], v[144:147]
  v_mfma_f32_16x16x32_bf16 v[148:151], v[112:115], v[12:15], v[148:151]
  v_mfma_f32_16x16x32_bf16 v[152:155], v[116:119], v[12:15], v[152:155]
  v_mfma_f32_16x16x32_bf16 v[156:159], v[120:123], v[12:15], v[156:159]
  v_mfma_f32_16x16x32_bf16 v[160:163], v[124:127], v[12:15], v[160:163]
  s_mov_b64 exec, s[52:53]
  ds_write_b128 v164, v[128:131] offset:0
  ds_write_b128 v164, v[132:135] offset:256
  ds_write_b128 v164, v[136:139] offset:512
  ds_write_b128 v164, v[140:143] offset:768
  ds_write_b128 v164, v[144:147] offset:1024
  ds_write_b128 v164, v[148:151] offset:1280
  ds_write_b128 v164, v[152:155] offset:1536
  ds_write_b128 v164, v[156:159] offset:1792
  ds_write_b128 v164, v[160:163] offset:2048
  s_mov_b64 exec, -1
  ds_read2st64_b32 v[20:21], v166 offset0:0 offset1:9
  ds_read2st64_b32 v[22:23], v166 offset0:1 offset1:10
  ds_read2st64_b32 v[24:25], v166 offset0:2 offset1:11
  ds_read2st64_b32 v[26:27], v166 offset0:3 offset1:12
  ds_read2st64_b32 v[28:29], v166 offset0:4 offset1:13
  ds_read2st64_b32 v[30:31], v166 offset0:5 offset1:14
  ds_read2st64_b32 v[32:33], v166 offset0:6 offset1:15
  ds_read2st64_b32 v[34:35], v166 offset0:7 offset1:16
  ds_read2st64_b32 v[36:37], v166 offset0:8 offset1:17
  s_mov_b32 s60, 0x200000
L_dn_at:
  ds_read_b32 v10, v3 offset:8
  s_waitcnt lgkmcnt(0)
  v_readfirstlane_b32 s61, v10
  s_nop 0
  s_bitcmp1_b32 s61, 3
  s_cbranch_scc1 L_dn_at_d
  s_sleep 2
  s_sub_u32 s60, s60, 1
  s_cmp_lg_u32 s60, 0
  s_cbranch_scc1 L_dn_at
L_dn_at_d:
  s_mov_b32 s60, 0x200000
L_dn_ax:
  ds_read_b32 v10, v3 offset:52
  s_waitcnt lgkmcnt(0)
  v_readfirstlane_b32 s61, v10
  s_nop 0
  s_cmp_eq_u32 s61, 1
  s_cbranch_scc1 L_dn_ax_d
  s_sleep 1
  s_sub_u32 s60, s60, 1
  s_cmp_lg_u32 s60, 0
  s_cbranch_scc1 L_dn_ax
L_dn_ax_d:
  v_add_f32 v20, v20, v21
  global_atomic_add_f32 v165, v20, s[8:9] offset:0
  v_add_f32 v22, v22, v23
  global_atomic_add_f32 v165, v22, s[8:9] offset:256
  v_add_f32 v24, v24, v25
  global_atomic_add_f32 v165, v24, s[8:9] offset:512
  v_add_f32 v26, v26, v27
  global_atomic_add_f32 v165, v26, s[8:9] offset:768
  v_add_f32 v28, v28, v29
  global_atomic_add_f32 v165, v28, s[8:9] offset:1024
  v_add_f32 v30, v30, v31
  global_atomic_add_f32 v165, v30, s[8:9] offset:1280
  v_add_f32 v32, v32, v33
  global_atomic_add_f32 v165, v32, s[8:9] offset:1536
  v_add_f32 v34, v34, v35
  global_atomic_add_f32 v165, v34, s[8:9] offset:1792
  v_add_f32 v36, v36, v37
  global_atomic_add_f32 v165, v36, s[8:9] offset:2048
  v_mov_b32 v4, s38
  v_mov_b32 v5, 1
  s_waitcnt vmcnt(0)
  s_mov_b64 exec, 1
  global_atomic_add v4, v5, s[8:9] sc1
L_end:
  s_endpgm
.section .rodata,"a"
.p2align 6
.amdhsa_kernel gated_mix__sliding_block__moe_arch_mod__prompt_kernel
  .amdhsa_next_free_vgpr 168
  .amdhsa_next_free_sgpr 102
  .amdhsa_accum_offset 168
  .amdhsa_group_segment_fixed_size 0
  .amdhsa_kernarg_size 96
  .amdhsa_user_sgpr_count 2
  .amdhsa_user_sgpr_kernarg_segment_ptr 1
  .amdhsa_system_sgpr_workgroup_id_x 1
.end_amdhsa_kernel
```
